```python
import torch

def _softmax(x, axis=-1):
    return torch.softmax(x, dim=axis)
def _gelu(x):
    return torch.nn.functional.gelu(x, approximate="tanh")
def _silu(x):
    return torch.nn.functional.silu(x)
def _sigmoid(x):
    return torch.sigmoid(x)
def _layernorm(x, axis=-1, eps=1e-5):
    m = x.mean(dim=axis, keepdim=True)
    v = x.var(dim=axis, keepdim=True, unbiased=False)
    return (x - m) / torch.sqrt(v + eps)
def _scatter_add(tgt, idx, src, axis=0):
    return tgt.clone().index_add_(axis, idx, src)
def _segment_sum(src, seg, n):
    out = torch.zeros((n,) + src.shape[1:], dtype=src.dtype)
    return out.index_add_(0, seg, src)
def _pad(x, pw):
    flat = tuple(v for pair in reversed(pw) for v in pair)
    return torch.nn.functional.pad(x, flat)

kernel_name = 'recurrent_scan__mha_block_cached__dense_activation_squared_relu__decode'

def setup_inputs():

    _w = (lambda a: (lambda t: t.to(torch.bfloat16) if t.is_floating_point() else t)(torch.as_tensor(a)))
    def _A_setup():
        B, Sq, D = 2, 1, 640
        H, Sk, Dh = 32, 8192, 128
        return {
            "x": _w((lambda *s: torch.randn(*s, dtype=torch.bfloat16) * 0.05)(B, Sq, D)),
            "k_cache": _w((lambda *s: torch.randn(*s, dtype=torch.bfloat16) * 0.8)(B, H, Sk, Dh)),
            "v_cache": _w((lambda *s: torch.randn(*s, dtype=torch.bfloat16) * 0.2)(B, H, Sk, Dh)),
            "wq": _w((lambda *s: torch.randn(*s, dtype=torch.bfloat16) * 0.8)(D, H * Dh) * (D ** -0.5)),
            "wo": _w((lambda *s: torch.randn(*s, dtype=torch.bfloat16) * 0.2)(H * Dh, D) * ((H * Dh) ** -0.5)),
        }
    _A_in = _A_setup()

    def _B_setup():
        B, S, D, F = 2, 1, 640, 1728
        return {
            "x": _w((lambda *s: torch.randn(*s, dtype=torch.bfloat16) * 0.05)(B, S, D)),
            "w1": _w((lambda *s: torch.randn(*s, dtype=torch.bfloat16) * 0.1)(D, F)),
            "b1": _w((lambda *s: torch.randn(*s, dtype=torch.bfloat16) * 0.1)(F)),
            "w2": _w((lambda *s: torch.randn(*s, dtype=torch.bfloat16) * 0.1)(F, D)),
            "b2": _w((lambda *s: torch.randn(*s, dtype=torch.bfloat16) * 0.1)(D)),
        }
    _B_in = _B_setup()

    return {
        "A_x": _A_in["x"],
        "A_k_cache": _A_in["k_cache"],
        "A_v_cache": _A_in["v_cache"],
        "A_wq": _A_in["wq"],
        "A_wo": _A_in["wo"],
        "B_x": _B_in["x"],
        "B_w1": _B_in["w1"],
        "B_b1": _B_in["b1"],
        "B_w2": _B_in["w2"],
        "B_b2": _B_in["b2"],
    }

def reference(A_x, A_k_cache, A_v_cache, A_wq, A_wo, B_x, B_w1, B_b1, B_w2, B_b2):
    def _A_ref(x, k_cache, v_cache, wq, wo):
        B, Sq, D = x.shape
        H, Dh = 32, 128
        q = (lambda x, *d: x.permute(*d))((x @ wq).reshape(B, Sq, H, Dh), 0, 2, 1, 3)
        scores = torch.einsum("bhqd,bhkd->bhqk", q, k_cache) * (Dh ** -0.5)
        p = _softmax(scores, axis=-1)
        o = torch.einsum("bhqk,bhkd->bhqd", p, v_cache)
        return (lambda x, *d: x.permute(*d))(o, 0, 2, 1, 3).reshape(B, Sq, H * Dh) @ wo

    def _B_ref(x, w1, b1, w2, b2):
        h = torch.einsum("bsd,df->bsf", x, w1) + b1
        zero = torch.zeros_like(h)
        r = torch.where(h > zero, h, zero)
        h = r * r
        out = torch.einsum("bsf,fd->bsd", h, w2) + b2
        return out

    x = A_x
    xn = _layernorm(x, axis=-1)
    s = _A_ref(xn, A_k_cache, A_v_cache, A_wq, A_wo)
    g = _silu(_B_ref(xn, B_w1, B_b1, B_w2, B_b2))
    return x + s * g
```

```asm
; @launch grid=(256,1,1) block=(448,1,1) lds=8704
.amdgcn_target "amdgcn-amd-amdhsa--gfx950"
.text
.globl recurrent_scan__mha_block_cached__dense_activation_squared_relu__decode_kernel
.p2align 8
.type recurrent_scan__mha_block_cached__dense_activation_squared_relu__decode_kernel,@function
recurrent_scan__mha_block_cached__dense_activation_squared_relu__decode_kernel:
    s_load_dwordx8 s[8:15], s[0:1], 0
    v_readfirstlane_b32 s3, v0
    s_lshr_b32 s35, s2, 6
    s_cmp_ge_u32 s35, 4
    s_cbranch_scc1 L_end
    s_and_b32 s34, s2, 7
    s_lshl_b32 s34, s34, 2
    s_add_u32 s34, s34, s35
    s_and_b32 s39, s2, 32
    s_add_u32 s35, s39, s34
    s_lshr_b32 s4, s2, 3
    s_and_b32 s37, s4, 3
    s_lshr_b32 s3, s3, 6
    v_and_b32 v1, 63, v0
    s_mov_b32 s43, 0x20000
    s_sub_u32 s38, s3, 3
    s_cbranch_scc1 L_helper
    s_lshl_b32 s56, s35, 2
    s_add_u32 s56, s56, s37
    s_lshl_b32 s56, s56, 7
    s_add_u32 s56, s56, s38
    s_lshl_b32 s56, s56, 12
    s_mov_b32 s42, 0x7d000
    v_lshlrev_b32 v1, 4, v1
    s_and_b32 s57, s2, 31
    s_lshl_b32 s57, s57, 14
    s_mov_b32 s58, 0x7ffff
    s_waitcnt lgkmcnt(0)
    s_add_u32 s40, s10, s56
    s_addc_u32 s41, s11, 0
    buffer_load_dwordx4 v[72:75], v1, s[40:43], s57 offen offset:0 nt
    buffer_load_dwordx4 v[76:79], v1, s[40:43], s57 offen offset:1024 nt
    buffer_load_dwordx4 v[80:83], v1, s[40:43], s57 offen offset:2048 nt
    buffer_load_dwordx4 v[84:87], v1, s[40:43], s57 offen offset:3072 nt
    s_addk_i32 s57, 0x4000
    s_and_b32 s57, s57, s58
    buffer_load_dwordx4 v[88:91], v1, s[40:43], s57 offen offset:0 nt
    buffer_load_dwordx4 v[92:95], v1, s[40:43], s57 offen offset:1024 nt
    s_load_dwordx8 s[16:23], s[0:1], 32
    s_load_dwordx8 s[24:31], s[0:1], 64
    s_load_dwordx2 s[32:33], s[0:1], 96
    s_and_b32 s4, s4, 7
    s_lshr_b32 s36, s4, 2
    s_mov_b32 s50, 4194304
    s_mov_b32 s51, 0x20000
    v_bfe_u32 v2, v0, 4, 2
    v_and_b32 v3, 15, v0
    v_and_b32 v39, 63, v0
    s_add_u32 s44, s12, s56
    s_addc_u32 s45, s13, 0
    s_lshl_b32 s39, s34, 2
    s_add_u32 s39, s39, s38
    s_mul_i32 s39, s39, 40960
    s_mul_i32 s5, s4, 160
    s_add_u32 s39, s39, s5
    v_mul_u32_u24 v16, 10240, v2
    v_lshl_add_u32 v16, v3, 4, v16
    v_mov_b32 v18, 0x40000000
    v_cmp_gt_u32 vcc, 10, v3
    s_nop 1
    v_cndmask_b32 v248, v18, v16, vcc
    s_waitcnt lgkmcnt(0)
    s_load_dwordx2 s[74:75], s[32:33], 49152
    s_add_u32 s52, s16, s39
    s_addc_u32 s53, s17, 0
    s_sub_u32 s54, 5242880, s39
    s_mov_b32 s55, 0x20000
    s_mov_b32 s48, s32
    s_mov_b32 s49, s33
    s_waitcnt vmcnt(5)
    buffer_load_dwordx4 v[96:99], v1, s[40:43], s57 offen offset:2048 nt
    s_waitcnt vmcnt(3)
    buffer_load_dwordx4 v[100:103], v1, s[40:43], s57 offen offset:3072 nt
    s_addk_i32 s57, 0x4000
    s_and_b32 s57, s57, s58
    s_waitcnt vmcnt(3)
    buffer_load_dwordx4 v[104:107], v1, s[40:43], s57 offen offset:0 nt
    s_waitcnt vmcnt(3)
    buffer_load_dwordx4 v[108:111], v1, s[40:43], s57 offen offset:1024 nt
    s_barrier
    s_waitcnt vmcnt(3)
    buffer_load_dwordx4 v[112:115], v1, s[40:43], s57 offen offset:2048 nt
    v_lshrrev_b32 v16, 1, v2
    v_mul_u32_u24 v16, 320, v16
    v_lshl_add_u32 v16, v3, 5, v16
    v_and_b32 v17, 1, v2
    v_lshl_add_u32 v16, v17, 4, v16
    v_cndmask_b32 v249, v18, v16, vcc
    s_lshl_b32 s99, s34, 3
    s_add_u32 s99, s99, s4
    s_mul_i32 s99, s99, 640
    s_add_u32 s99, s99, 2097152
    v_lshlrev_b32 v16, 8, v3
    v_lshl_add_u32 v16, v17, 6, v16
    v_lshrrev_b32 v17, 1, v2
    v_lshl_add_u32 v38, v17, 24, v16
    s_lshl_b32 s64, s34, 12
    s_add_u32 s64, s64, 524288
    s_lshl_b32 s66, s36, 7
    s_lshl_b32 s39, s37, 4
    s_add_u32 s66, s66, s39
    s_add_u32 s66, s66, s64
    s_lshl_b32 s39, s38, 10
    s_add_u32 s47, s64, s39
    v_add_u32 v250, s39, v1
    v_mov_b32 v251, 1
    s_waitcnt vmcnt(3)
    buffer_load_dwordx4 v[116:119], v1, s[40:43], s57 offen offset:3072 nt
    s_addk_i32 s57, 0x4000
    s_and_b32 s57, s57, s58
    s_waitcnt vmcnt(3)
    buffer_load_dwordx4 v[120:123], v1, s[40:43], s57 offen offset:0 nt
    s_setprio 1
    v_and_b32 v24, 7, v3
    v_lshrrev_b32 v25, 1, v24
    v_and_b32 v24, 1, v24
    v_mov_b32 v26, 0x0c0c0c0c
    v_cmp_eq_u32 vcc, 1, v24
    v_mov_b32 v27, 0x0c0c0100
    v_mov_b32 v28, 0x01000c0c
    v_cndmask_b32 v27, v27, v28, vcc
    v_mov_b32 v29, 0x0c0c0302
    v_mov_b32 v28, 0x03020c0c
    v_cndmask_b32 v29, v29, v28, vcc
    v_cmp_eq_u32 vcc, 0, v25
    s_nop 1
    v_cndmask_b32 v240, v26, v27, vcc
    v_cndmask_b32 v244, v26, v29, vcc
    v_cmp_eq_u32 vcc, 1, v25
    s_nop 1
    v_cndmask_b32 v241, v26, v27, vcc
    v_cndmask_b32 v245, v26, v29, vcc
    v_cmp_eq_u32 vcc, 2, v25
    s_nop 1
    v_cndmask_b32 v242, v26, v27, vcc
    v_cndmask_b32 v246, v26, v29, vcc
    v_cmp_eq_u32 vcc, 3, v25
    s_nop 1
    v_cndmask_b32 v243, v26, v27, vcc
    v_cndmask_b32 v247, v26, v29, vcc
    s_waitcnt vmcnt(3)
    buffer_load_dwordx4 v[124:127], v1, s[40:43], s57 offen offset:1024 nt
    s_waitcnt vmcnt(4)
    buffer_load_dwordx4 v[128:131], v1, s[40:43], s57 offen offset:2048 nt
    v_and_b32 v16, 1, v3
    v_lshlrev_b32 v16, 4, v16
    v_mov_b32 v17, 0xffff
    v_lshlrev_b32 v16, v16, v17
    v_lshrrev_b32 v17, 1, v3
    v_cmp_eq_u32 vcc, 0, v17
    s_nop 1
    v_cndmask_b32 v8, 0, v16, vcc
    v_cmp_eq_u32 vcc, 1, v17
    s_nop 1
    v_cndmask_b32 v9, 0, v16, vcc
    v_cmp_eq_u32 vcc, 2, v17
    s_nop 1
    v_cndmask_b32 v10, 0, v16, vcc
    v_cmp_eq_u32 vcc, 3, v17
    s_nop 1
    v_cndmask_b32 v11, 0, v16, vcc
    v_lshlrev_b32 v3, 4, v3
    v_mov_b32 v2, 256
    v_mov_b32 v32, 0xff7fffff
    v_mov_b32 v33, 0
    v_mov_b32 v12, 0
    v_mov_b32 v13, 0
    v_mov_b32 v14, 0
    v_mov_b32 v15, 0
    s_mov_b32 s61, 0x3e0293ee
    s_waitcnt vmcnt(4)
    buffer_load_dwordx4 v[132:135], v1, s[40:43], s57 offen offset:3072 nt
    s_addk_i32 s57, 0x4000
    s_and_b32 s57, s57, s58
    s_waitcnt vmcnt(4)
    buffer_load_dwordx4 v[136:139], v1, s[40:43], s57 offen offset:0 nt
    s_waitcnt lgkmcnt(0)
    s_add_u32 s74, s74, 0x7f4a7c15
    s_addc_u32 s75, s75, 0x9e3779b9
    s_and_b32 s70, s74, 0xfff
    s_bfe_u32 s71, s74, 0xc000c
    s_lshr_b64 s[72:73], s[74:75], 24
    s_bfe_u32 s73, s72, 0xc000c
    s_and_b32 s72, s72, 0xfff
    v_mov_b32 v200, s70
    v_mov_b32 v201, s71
    v_mov_b32 v202, s72
    v_mov_b32 v203, s73
    v_mov_b32 v204, 0xfff
    s_waitcnt vmcnt(4)
    buffer_load_dwordx4 v[140:143], v1, s[40:43], s57 offen offset:1024 nt
    s_waitcnt vmcnt(4)
    buffer_load_dwordx4 v[144:147], v1, s[40:43], s57 offen offset:2048 nt
    s_waitcnt vmcnt(4)
    buffer_load_dwordx4 v[148:151], v1, s[40:43], s57 offen offset:3072 nt
    s_addk_i32 s57, 0x4000
    s_and_b32 s57, s57, s58
    s_waitcnt vmcnt(4)
    buffer_load_dwordx4 v[152:155], v1, s[40:43], s57 offen offset:0 nt
    s_waitcnt vmcnt(4)
    buffer_load_dwordx4 v[156:159], v1, s[40:43], s57 offen offset:1024 nt
    s_waitcnt vmcnt(4)
    buffer_load_dwordx4 v[160:163], v1, s[40:43], s57 offen offset:2048 nt
    s_waitcnt vmcnt(4)
    buffer_load_dwordx4 v[164:167], v1, s[40:43], s57 offen offset:3072 nt
    s_addk_i32 s57, 0x4000
    s_and_b32 s57, s57, s58
    s_waitcnt vmcnt(4)
    buffer_load_dwordx4 v[168:171], v1, s[40:43], s57 offen offset:0 nt
    s_waitcnt vmcnt(4)
    buffer_load_dwordx4 v[172:175], v1, s[40:43], s57 offen offset:1024 nt
    s_waitcnt vmcnt(4)
    buffer_load_dwordx4 v[176:179], v1, s[40:43], s57 offen offset:2048 nt
    s_waitcnt vmcnt(4)
    buffer_load_dwordx4 v[180:183], v1, s[40:43], s57 offen offset:3072 nt
    s_addk_i32 s57, 0x4000
    s_and_b32 s57, s57, s58
    s_waitcnt vmcnt(4)
    buffer_load_dwordx4 v[184:187], v1, s[40:43], s57 offen offset:0 nt
    s_waitcnt vmcnt(4)
    buffer_load_dwordx4 v[188:191], v1, s[40:43], s57 offen offset:1024 nt
    s_waitcnt vmcnt(4)
    buffer_load_dwordx4 v[192:195], v1, s[40:43], s57 offen offset:2048 nt
    s_waitcnt vmcnt(4)
    buffer_load_dwordx4 v[196:199], v1, s[40:43], s57 offen offset:3072 nt
    s_mov_b32 s67, 1048576
    v_mov_b32 v16, 272
L_pw1:
    ds_read_b32 v17, v16
    s_waitcnt lgkmcnt(0)
    v_readfirstlane_b32 s39, v17
    s_cmp_ge_u32 s39, 1
    s_cbranch_scc1 L_pd1
    s_sleep 1
    s_sub_u32 s67, s67, 1
    s_cmp_lg_u32 s67, 0
    s_cbranch_scc1 L_pw1
L_pd1:
    ds_read_b128 v[4:7], v3 offset:0
    s_mov_b32 s59, 0
    s_waitcnt lgkmcnt(0)
L_kloop:
    s_cmp_eq_u32 s59, 3
    s_cselect_b32 s40, s44, s40
    s_cselect_b32 s41, s45, s41
    s_add_u32 s59, s59, 1
    v_mov_b32 v37, s59
    ds_max_u32 v2, v37
    v_dot2_f32_bf16 v24, v72, v4, 0
    v_dot2_f32_bf16 v25, v76, v4, 0
    v_dot2_f32_bf16 v26, v80, v4, 0
    v_dot2_f32_bf16 v27, v84, v4, 0
    v_dot2c_f32_bf16 v24, v73, v5
    v_dot2c_f32_bf16 v25, v77, v5
    v_dot2c_f32_bf16 v26, v81, v5
    v_dot2c_f32_bf16 v27, v85, v5
    v_dot2c_f32_bf16 v24, v74, v6
    v_dot2c_f32_bf16 v25, v78, v6
    v_dot2c_f32_bf16 v26, v82, v6
    v_dot2c_f32_bf16 v27, v86, v6
    v_dot2c_f32_bf16 v24, v75, v7
    v_dot2c_f32_bf16 v25, v79, v7
    v_dot2c_f32_bf16 v26, v83, v7
    v_dot2c_f32_bf16 v27, v87, v7
    s_addk_i32 s57, 0x4000
    s_and_b32 s57, s57, s58
    s_waitcnt vmcnt(4)
    buffer_load_dwordx4 v[72:75], v1, s[40:43], s57 offen offset:0 nt
    v_add_f32_dpp v28, v24, v24 row_ror:8 row_mask:0xf bank_mask:0xf
    v_add_f32_dpp v29, v26, v26 row_ror:8 row_mask:0xf bank_mask:0xf
    v_add_f32_dpp v28, v25, v25 row_ror:8 row_mask:0xf bank_mask:0xc
    v_add_f32_dpp v29, v27, v27 row_ror:8 row_mask:0xf bank_mask:0xc
    v_mov_b32 v40, v48
    v_add_f32_dpp v30, v28, v28 row_half_mirror row_mask:0xf bank_mask:0xf
    v_add_f32_dpp v30, v29, v29 row_half_mirror row_mask:0xf bank_mask:0xa
    v_mov_b32 v48, v56
    v_mov_b32 v56, v64
    v_add_f32_dpp v31, v30, v30 quad_perm:[1,0,3,2] row_mask:0xf bank_mask:0xf
    s_waitcnt vmcnt(4)
    buffer_load_dwordx4 v[76:79], v1, s[40:43], s57 offen offset:1024 nt
    v_add_f32_dpp v30, v31, v31 quad_perm:[2,3,0,1] row_mask:0xf bank_mask:0xf
    v_mul_f32 v64, s61, v30
    v_max_f32 v34, v32, v64
    v_sub_f32 v35, v32, v34
    v_sub_f32 v36, v64, v34
    v_exp_f32 v35, v35
    v_exp_f32 v36, v36
    v_mov_b32 v32, v34
    v_fma_f32 v33, v33, v35, v36
    s_waitcnt vmcnt(4)
    buffer_load_dwordx4 v[80:83], v1, s[40:43], s57 offen offset:2048 nt
    s_waitcnt vmcnt(4)
    buffer_load_dwordx4 v[84:87], v1, s[40:43], s57 offen offset:3072 nt
    v_dot2_f32_bf16 v24, v88, v4, 0
    v_dot2_f32_bf16 v25, v92, v4, 0
    v_dot2_f32_bf16 v26, v96, v4, 0
    v_dot2_f32_bf16 v27, v100, v4, 0
    v_dot2c_f32_bf16 v24, v89, v5
    v_dot2c_f32_bf16 v25, v93, v5
    v_dot2c_f32_bf16 v26, v97, v5
    v_dot2c_f32_bf16 v27, v101, v5
    v_dot2c_f32_bf16 v24, v90, v6
    v_dot2c_f32_bf16 v25, v94, v6
    v_dot2c_f32_bf16 v26, v98, v6
    v_dot2c_f32_bf16 v27, v102, v6
    v_dot2c_f32_bf16 v24, v91, v7
    v_dot2c_f32_bf16 v25, v95, v7
    v_dot2c_f32_bf16 v26, v99, v7
    v_dot2c_f32_bf16 v27, v103, v7
    s_addk_i32 s57, 0x4000
    s_and_b32 s57, s57, s58
    s_waitcnt vmcnt(4)
    buffer_load_dwordx4 v[88:91], v1, s[40:43], s57 offen offset:0 nt
    v_add_f32_dpp v28, v24, v24 row_ror:8 row_mask:0xf bank_mask:0xf
    v_add_f32_dpp v29, v26, v26 row_ror:8 row_mask:0xf bank_mask:0xf
    v_add_f32_dpp v28, v25, v25 row_ror:8 row_mask:0xf bank_mask:0xc
    v_add_f32_dpp v29, v27, v27 row_ror:8 row_mask:0xf bank_mask:0xc
    v_mov_b32 v41, v49
    v_add_f32_dpp v30, v28, v28 row_half_mirror row_mask:0xf bank_mask:0xf
    v_add_f32_dpp v30, v29, v29 row_half_mirror row_mask:0xf bank_mask:0xa
    v_mov_b32 v49, v57
    v_mov_b32 v57, v65
    v_add_f32_dpp v31, v30, v30 quad_perm:[1,0,3,2] row_mask:0xf bank_mask:0xf
    s_waitcnt vmcnt(4)
    buffer_load_dwordx4 v[92:95], v1, s[40:43], s57 offen offset:1024 nt
    v_add_f32_dpp v30, v31, v31 quad_perm:[2,3,0,1] row_mask:0xf bank_mask:0xf
    v_mul_f32 v65, s61, v30
    v_max_f32 v34, v32, v65
    v_sub_f32 v35, v32, v34
    v_sub_f32 v36, v65, v34
    v_exp_f32 v35, v35
    v_exp_f32 v36, v36
    v_mov_b32 v32, v34
    v_fma_f32 v33, v33, v35, v36
    s_waitcnt vmcnt(4)
    buffer_load_dwordx4 v[96:99], v1, s[40:43], s57 offen offset:2048 nt
    s_waitcnt vmcnt(4)
    buffer_load_dwordx4 v[100:103], v1, s[40:43], s57 offen offset:3072 nt
    v_dot2_f32_bf16 v24, v104, v4, 0
    v_dot2_f32_bf16 v25, v108, v4, 0
    v_dot2_f32_bf16 v26, v112, v4, 0
    v_dot2_f32_bf16 v27, v116, v4, 0
    v_dot2c_f32_bf16 v24, v105, v5
    v_dot2c_f32_bf16 v25, v109, v5
    v_dot2c_f32_bf16 v26, v113, v5
    v_dot2c_f32_bf16 v27, v117, v5
    v_dot2c_f32_bf16 v24, v106, v6
    v_dot2c_f32_bf16 v25, v110, v6
    v_dot2c_f32_bf16 v26, v114, v6
    v_dot2c_f32_bf16 v27, v118, v6
    v_dot2c_f32_bf16 v24, v107, v7
    v_dot2c_f32_bf16 v25, v111, v7
    v_dot2c_f32_bf16 v26, v115, v7
    v_dot2c_f32_bf16 v27, v119, v7
    s_addk_i32 s57, 0x4000
    s_and_b32 s57, s57, s58
    s_waitcnt vmcnt(4)
    buffer_load_dwordx4 v[104:107], v1, s[40:43], s57 offen offset:0 nt
    v_add_f32_dpp v28, v24, v24 row_ror:8 row_mask:0xf bank_mask:0xf
    v_add_f32_dpp v29, v26, v26 row_ror:8 row_mask:0xf bank_mask:0xf
    v_add_f32_dpp v28, v25, v25 row_ror:8 row_mask:0xf bank_mask:0xc
    v_add_f32_dpp v29, v27, v27 row_ror:8 row_mask:0xf bank_mask:0xc
    v_mov_b32 v42, v50
    v_add_f32_dpp v30, v28, v28 row_half_mirror row_mask:0xf bank_mask:0xf
    v_add_f32_dpp v30, v29, v29 row_half_mirror row_mask:0xf bank_mask:0xa
    v_mov_b32 v50, v58
    v_mov_b32 v58, v66
    v_add_f32_dpp v31, v30, v30 quad_perm:[1,0,3,2] row_mask:0xf bank_mask:0xf
    s_waitcnt vmcnt(4)
    buffer_load_dwordx4 v[108:111], v1, s[40:43], s57 offen offset:1024 nt
    v_add_f32_dpp v30, v31, v31 quad_perm:[2,3,0,1] row_mask:0xf bank_mask:0xf
    v_mul_f32 v66, s61, v30
    v_max_f32 v34, v32, v66
    v_sub_f32 v35, v32, v34
    v_sub_f32 v36, v66, v34
    v_exp_f32 v35, v35
    v_exp_f32 v36, v36
    v_mov_b32 v32, v34
    v_fma_f32 v33, v33, v35, v36
    s_waitcnt vmcnt(4)
    buffer_load_dwordx4 v[112:115], v1, s[40:43], s57 offen offset:2048 nt
    s_waitcnt vmcnt(4)
    buffer_load_dwordx4 v[116:119], v1, s[40:43], s57 offen offset:3072 nt
    v_dot2_f32_bf16 v24, v120, v4, 0
    v_dot2_f32_bf16 v25, v124, v4, 0
    v_dot2_f32_bf16 v26, v128, v4, 0
    v_dot2_f32_bf16 v27, v132, v4, 0
    v_dot2c_f32_bf16 v24, v121, v5
    v_dot2c_f32_bf16 v25, v125, v5
    v_dot2c_f32_bf16 v26, v129, v5
    v_dot2c_f32_bf16 v27, v133, v5
    v_dot2c_f32_bf16 v24, v122, v6
    v_dot2c_f32_bf16 v25, v126, v6
    v_dot2c_f32_bf16 v26, v130, v6
    v_dot2c_f32_bf16 v27, v134, v6
    v_dot2c_f32_bf16 v24, v123, v7
    v_dot2c_f32_bf16 v25, v127, v7
    v_dot2c_f32_bf16 v26, v131, v7
    v_dot2c_f32_bf16 v27, v135, v7
    s_addk_i32 s57, 0x4000
    s_and_b32 s57, s57, s58
    s_waitcnt vmcnt(4)
    buffer_load_dwordx4 v[120:123], v1, s[40:43], s57 offen offset:0 nt
    v_add_f32_dpp v28, v24, v24 row_ror:8 row_mask:0xf bank_mask:0xf
    v_add_f32_dpp v29, v26, v26 row_ror:8 row_mask:0xf bank_mask:0xf
    v_add_f32_dpp v28, v25, v25 row_ror:8 row_mask:0xf bank_mask:0xc
    v_add_f32_dpp v29, v27, v27 row_ror:8 row_mask:0xf bank_mask:0xc
    v_mov_b32 v43, v51
    v_add_f32_dpp v30, v28, v28 row_half_mirror row_mask:0xf bank_mask:0xf
    v_add_f32_dpp v30, v29, v29 row_half_mirror row_mask:0xf bank_mask:0xa
    v_mov_b32 v51, v59
    v_mov_b32 v59, v67
    v_add_f32_dpp v31, v30, v30 quad_perm:[1,0,3,2] row_mask:0xf bank_mask:0xf
    s_waitcnt vmcnt(4)
    buffer_load_dwordx4 v[124:127], v1, s[40:43], s57 offen offset:1024 nt
    v_add_f32_dpp v30, v31, v31 quad_perm:[2,3,0,1] row_mask:0xf bank_mask:0xf
    v_mul_f32 v67, s61, v30
    v_max_f32 v34, v32, v67
    v_sub_f32 v35, v32, v34
    v_sub_f32 v36, v67, v34
    v_exp_f32 v35, v35
    v_exp_f32 v36, v36
    v_mov_b32 v32, v34
    v_fma_f32 v33, v33, v35, v36
    s_waitcnt vmcnt(4)
    buffer_load_dwordx4 v[128:131], v1, s[40:43], s57 offen offset:2048 nt
    s_waitcnt vmcnt(4)
    buffer_load_dwordx4 v[132:135], v1, s[40:43], s57 offen offset:3072 nt
    v_dot2_f32_bf16 v24, v136, v4, 0
    v_dot2_f32_bf16 v25, v140, v4, 0
    v_dot2_f32_bf16 v26, v144, v4, 0
    v_dot2_f32_bf16 v27, v148, v4, 0
    v_dot2c_f32_bf16 v24, v137, v5
    v_dot2c_f32_bf16 v25, v141, v5
    v_dot2c_f32_bf16 v26, v145, v5
    v_dot2c_f32_bf16 v27, v149, v5
    v_dot2c_f32_bf16 v24, v138, v6
    v_dot2c_f32_bf16 v25, v142, v6
    v_dot2c_f32_bf16 v26, v146, v6
    v_dot2c_f32_bf16 v27, v150, v6
    v_dot2c_f32_bf16 v24, v139, v7
    v_dot2c_f32_bf16 v25, v143, v7
    v_dot2c_f32_bf16 v26, v147, v7
    v_dot2c_f32_bf16 v27, v151, v7
    s_addk_i32 s57, 0x4000
    s_and_b32 s57, s57, s58
    s_waitcnt vmcnt(4)
    buffer_load_dwordx4 v[136:139], v1, s[40:43], s57 offen offset:0 nt
    v_add_f32_dpp v28, v24, v24 row_ror:8 row_mask:0xf bank_mask:0xf
    v_add_f32_dpp v29, v26, v26 row_ror:8 row_mask:0xf bank_mask:0xf
    v_add_f32_dpp v28, v25, v25 row_ror:8 row_mask:0xf bank_mask:0xc
    v_add_f32_dpp v29, v27, v27 row_ror:8 row_mask:0xf bank_mask:0xc
    v_mov_b32 v44, v52
    v_add_f32_dpp v30, v28, v28 row_half_mirror row_mask:0xf bank_mask:0xf
    v_add_f32_dpp v30, v29, v29 row_half_mirror row_mask:0xf bank_mask:0xa
    v_mov_b32 v52, v60
    v_mov_b32 v60, v68
    v_add_f32_dpp v31, v30, v30 quad_perm:[1,0,3,2] row_mask:0xf bank_mask:0xf
    s_waitcnt vmcnt(4)
    buffer_load_dwordx4 v[140:143], v1, s[40:43], s57 offen offset:1024 nt
    v_add_f32_dpp v30, v31, v31 quad_perm:[2,3,0,1] row_mask:0xf bank_mask:0xf
    v_mul_f32 v68, s61, v30
    v_max_f32 v34, v32, v68
    v_sub_f32 v35, v32, v34
    v_sub_f32 v36, v68, v34
    v_exp_f32 v35, v35
    v_exp_f32 v36, v36
    v_mov_b32 v32, v34
    v_fma_f32 v33, v33, v35, v36
    s_waitcnt vmcnt(4)
    buffer_load_dwordx4 v[144:147], v1, s[40:43], s57 offen offset:2048 nt
    s_waitcnt vmcnt(4)
    buffer_load_dwordx4 v[148:151], v1, s[40:43], s57 offen offset:3072 nt
    v_dot2_f32_bf16 v24, v152, v4, 0
    v_dot2_f32_bf16 v25, v156, v4, 0
    v_dot2_f32_bf16 v26, v160, v4, 0
    v_dot2_f32_bf16 v27, v164, v4, 0
    v_dot2c_f32_bf16 v24, v153, v5
    v_dot2c_f32_bf16 v25, v157, v5
    v_dot2c_f32_bf16 v26, v161, v5
    v_dot2c_f32_bf16 v27, v165, v5
    v_dot2c_f32_bf16 v24, v154, v6
    v_dot2c_f32_bf16 v25, v158, v6
    v_dot2c_f32_bf16 v26, v162, v6
    v_dot2c_f32_bf16 v27, v166, v6
    v_dot2c_f32_bf16 v24, v155, v7
    v_dot2c_f32_bf16 v25, v159, v7
    v_dot2c_f32_bf16 v26, v163, v7
    v_dot2c_f32_bf16 v27, v167, v7
    s_addk_i32 s57, 0x4000
    s_and_b32 s57, s57, s58
    s_waitcnt vmcnt(4)
    buffer_load_dwordx4 v[152:155], v1, s[40:43], s57 offen offset:0 nt
    v_add_f32_dpp v28, v24, v24 row_ror:8 row_mask:0xf bank_mask:0xf
    v_add_f32_dpp v29, v26, v26 row_ror:8 row_mask:0xf bank_mask:0xf
    v_add_f32_dpp v28, v25, v25 row_ror:8 row_mask:0xf bank_mask:0xc
    v_add_f32_dpp v29, v27, v27 row_ror:8 row_mask:0xf bank_mask:0xc
    v_mov_b32 v45, v53
    v_add_f32_dpp v30, v28, v28 row_half_mirror row_mask:0xf bank_mask:0xf
    v_add_f32_dpp v30, v29, v29 row_half_mirror row_mask:0xf bank_mask:0xa
    v_mov_b32 v53, v61
    v_mov_b32 v61, v69
    v_add_f32_dpp v31, v30, v30 quad_perm:[1,0,3,2] row_mask:0xf bank_mask:0xf
    s_waitcnt vmcnt(4)
    buffer_load_dwordx4 v[156:159], v1, s[40:43], s57 offen offset:1024 nt
    v_add_f32_dpp v30, v31, v31 quad_perm:[2,3,0,1] row_mask:0xf bank_mask:0xf
    v_mul_f32 v69, s61, v30
    v_max_f32 v34, v32, v69
    v_sub_f32 v35, v32, v34
    v_sub_f32 v36, v69, v34
    v_exp_f32 v35, v35
    v_exp_f32 v36, v36
    v_mov_b32 v32, v34
    v_fma_f32 v33, v33, v35, v36
    s_waitcnt vmcnt(4)
    buffer_load_dwordx4 v[160:163], v1, s[40:43], s57 offen offset:2048 nt
    s_waitcnt vmcnt(4)
    buffer_load_dwordx4 v[164:167], v1, s[40:43], s57 offen offset:3072 nt
    v_dot2_f32_bf16 v24, v168, v4, 0
    v_dot2_f32_bf16 v25, v172, v4, 0
    v_dot2_f32_bf16 v26, v176, v4, 0
    v_dot2_f32_bf16 v27, v180, v4, 0
    v_dot2c_f32_bf16 v24, v169, v5
    v_dot2c_f32_bf16 v25, v173, v5
    v_dot2c_f32_bf16 v26, v177, v5
    v_dot2c_f32_bf16 v27, v181, v5
    v_dot2c_f32_bf16 v24, v170, v6
    v_dot2c_f32_bf16 v25, v174, v6
    v_dot2c_f32_bf16 v26, v178, v6
    v_dot2c_f32_bf16 v27, v182, v6
    v_dot2c_f32_bf16 v24, v171, v7
    v_dot2c_f32_bf16 v25, v175, v7
    v_dot2c_f32_bf16 v26, v179, v7
    v_dot2c_f32_bf16 v27, v183, v7
    s_addk_i32 s57, 0x4000
    s_and_b32 s57, s57, s58
    s_waitcnt vmcnt(4)
    buffer_load_dwordx4 v[168:171], v1, s[40:43], s57 offen offset:0 nt
    v_add_f32_dpp v28, v24, v24 row_ror:8 row_mask:0xf bank_mask:0xf
    v_add_f32_dpp v29, v26, v26 row_ror:8 row_mask:0xf bank_mask:0xf
    v_add_f32_dpp v28, v25, v25 row_ror:8 row_mask:0xf bank_mask:0xc
    v_add_f32_dpp v29, v27, v27 row_ror:8 row_mask:0xf bank_mask:0xc
    v_mov_b32 v46, v54
    v_add_f32_dpp v30, v28, v28 row_half_mirror row_mask:0xf bank_mask:0xf
    v_add_f32_dpp v30, v29, v29 row_half_mirror row_mask:0xf bank_mask:0xa
    v_mov_b32 v54, v62
    v_mov_b32 v62, v70
    v_add_f32_dpp v31, v30, v30 quad_perm:[1,0,3,2] row_mask:0xf bank_mask:0xf
    s_waitcnt vmcnt(4)
    buffer_load_dwordx4 v[172:175], v1, s[40:43], s57 offen offset:1024 nt
    v_add_f32_dpp v30, v31, v31 quad_perm:[2,3,0,1] row_mask:0xf bank_mask:0xf
    v_mul_f32 v70, s61, v30
    v_max_f32 v34, v32, v70
    v_sub_f32 v35, v32, v34
    v_sub_f32 v36, v70, v34
    v_exp_f32 v35, v35
    v_exp_f32 v36, v36
    v_mov_b32 v32, v34
    v_fma_f32 v33, v33, v35, v36
    s_waitcnt vmcnt(4)
    buffer_load_dwordx4 v[176:179], v1, s[40:43], s57 offen offset:2048 nt
    s_waitcnt vmcnt(4)
    buffer_load_dwordx4 v[180:183], v1, s[40:43], s57 offen offset:3072 nt
    v_dot2_f32_bf16 v24, v184, v4, 0
    v_dot2_f32_bf16 v25, v188, v4, 0
    v_dot2_f32_bf16 v26, v192, v4, 0
    v_dot2_f32_bf16 v27, v196, v4, 0
    v_dot2c_f32_bf16 v24, v185, v5
    v_dot2c_f32_bf16 v25, v189, v5
    v_dot2c_f32_bf16 v26, v193, v5
    v_dot2c_f32_bf16 v27, v197, v5
    v_dot2c_f32_bf16 v24, v186, v6
    v_dot2c_f32_bf16 v25, v190, v6
    v_dot2c_f32_bf16 v26, v194, v6
    v_dot2c_f32_bf16 v27, v198, v6
    v_dot2c_f32_bf16 v24, v187, v7
    v_dot2c_f32_bf16 v25, v191, v7
    v_dot2c_f32_bf16 v26, v195, v7
    v_dot2c_f32_bf16 v27, v199, v7
    s_addk_i32 s57, 0x4000
    s_and_b32 s57, s57, s58
    s_waitcnt vmcnt(4)
    buffer_load_dwordx4 v[184:187], v1, s[40:43], s57 offen offset:0 nt
    v_add_f32_dpp v28, v24, v24 row_ror:8 row_mask:0xf bank_mask:0xf
    v_add_f32_dpp v29, v26, v26 row_ror:8 row_mask:0xf bank_mask:0xf
    v_add_f32_dpp v28, v25, v25 row_ror:8 row_mask:0xf bank_mask:0xc
    v_add_f32_dpp v29, v27, v27 row_ror:8 row_mask:0xf bank_mask:0xc
    v_mov_b32 v47, v55
    v_add_f32_dpp v30, v28, v28 row_half_mirror row_mask:0xf bank_mask:0xf
    v_add_f32_dpp v30, v29, v29 row_half_mirror row_mask:0xf bank_mask:0xa
    v_mov_b32 v55, v63
    v_mov_b32 v63, v71
    v_add_f32_dpp v31, v30, v30 quad_perm:[1,0,3,2] row_mask:0xf bank_mask:0xf
    s_waitcnt vmcnt(4)
    buffer_load_dwordx4 v[188:191], v1, s[40:43], s57 offen offset:1024 nt
    v_add_f32_dpp v30, v31, v31 quad_perm:[2,3,0,1] row_mask:0xf bank_mask:0xf
    v_mul_f32 v71, s61, v30
    v_max_f32 v34, v32, v71
    v_sub_f32 v35, v32, v34
    v_sub_f32 v36, v71, v34
    v_exp_f32 v35, v35
    v_exp_f32 v36, v36
    v_mov_b32 v32, v34
    v_fma_f32 v33, v33, v35, v36
    s_waitcnt vmcnt(4)
    buffer_load_dwordx4 v[192:195], v1, s[40:43], s57 offen offset:2048 nt
    s_waitcnt vmcnt(4)
    buffer_load_dwordx4 v[196:199], v1, s[40:43], s57 offen offset:3072 nt
    s_cmp_lt_u32 s59, 4
    s_cbranch_scc1 L_kloop
    v_max_f32_dpp v35, v32, v32 row_ror:4 row_mask:0xf bank_mask:0xf
    s_nop 1
    v_max_f32_dpp v36, v35, v35 row_ror:8 row_mask:0xf bank_mask:0xf
    s_nop 1
    v_max_f32_dpp v36, v36, v36 row_bcast:15 row_mask:0xa bank_mask:0xf
    s_nop 1
    v_max_f32_dpp v36, v36, v36 row_bcast:31 row_mask:0xc bank_mask:0xf
    s_nop 0
    v_readlane_b32 s60, v36, 63
    s_nop 1
    v_subrev_f32 v35, s60, v32
    v_exp_f32 v35, v35
    s_nop 0
    v_mul_f32 v33, v33, v35
    s_nop 1
    v_add_f32_dpp v35, v33, v33 row_ror:4 row_mask:0xf bank_mask:0xf
    s_nop 1
    v_add_f32_dpp v36, v35, v35 row_ror:8 row_mask:0xf bank_mask:0xf
    s_nop 1
    v_add_f32_dpp v36, v36, v36 row_bcast:15 row_mask:0xa bank_mask:0xf
    s_nop 1
    v_add_f32_dpp v36, v36, v36 row_bcast:31 row_mask:0xc bank_mask:0xf
    s_nop 0
    v_readlane_b32 s64, v36, 63
    v_mov_b32 v24, s60
    v_mov_b32 v25, s74
    v_lshlrev_b32 v30, 24, v39
    v_mov_b32 v26, s64
    v_mov_b32 v27, s75
    s_lshl_b32 s39, s38, 4
    v_mov_b32 v30, s39
    s_mov_b64 exec, 1
    ds_write_b128 v30, v[24:27] offset:320
    ds_add_u32 v2, v251 offset:28
    s_mov_b64 exec, -1
    s_mov_b64 vcc, 0
    s_mov_b32 s7, 0
    s_mov_b32 s98, 0
    ds_read_b128 v[32:35], v2
    s_memrealtime s[96:97]
L_vloop:
    s_add_u32 s59, s59, 1
    v_mov_b32 v37, s59
    ds_max_u32 v2, v37
    s_cmp_lg_u32 s59, 8
    s_cbranch_scc1 L_now
    s_movk_i32 s39, 0
    buffer_load_dwordx4 v[208:211], v248, s[52:55], s39 offen nt
    s_movk_i32 s39, 1280
    buffer_load_dwordx4 v[212:215], v248, s[52:55], s39 offen nt
    s_movk_i32 s39, 2560
    buffer_load_dwordx4 v[216:219], v248, s[52:55], s39 offen nt
    s_movk_i32 s39, 3840
    buffer_load_dwordx4 v[220:223], v248, s[52:55], s39 offen nt
    s_mov_b32 s67, 1048576
    v_mov_b32 v24, 260
L_pw2:
    ds_read_b32 v25, v24
    s_waitcnt lgkmcnt(0)
    v_readfirstlane_b32 s39, v25
    s_cmp_ge_u32 s39, 1
    s_cbranch_scc1 L_pd2
    s_sleep 1
    s_sub_u32 s67, s67, 1
    s_cmp_lg_u32 s67, 0
    s_cbranch_scc1 L_pw2
L_pd2:
    s_mov_b32 s46, s39
    s_lshl_b32 s39, s38, 2
    v_mov_b32 v24, s39
    ds_read_b32 v36, v24 offset:288
L_now:
    v_subrev_f32 v28, s60, v40
    v_exp_f32 v28, v28
    v_mov_b32 v40, v48
    v_cvt_pk_bf16_f32 v29, v28, v28
    v_mov_b32 v48, v56
    v_mov_b32 v56, v64
    v_and_b32 v16, v29, v8
    v_and_b32_dpp v17, v29, v9 row_ror:2 row_mask:0xf bank_mask:0xf
    v_and_b32_dpp v18, v29, v10 row_ror:4 row_mask:0xf bank_mask:0xf
    v_and_b32_dpp v19, v29, v11 row_ror:6 row_mask:0xf bank_mask:0xf
    v_and_b32_dpp v20, v29, v8 row_ror:8 row_mask:0xf bank_mask:0xf
    v_and_b32_dpp v21, v29, v9 row_ror:10 row_mask:0xf bank_mask:0xf
    v_and_b32_dpp v22, v29, v10 row_ror:12 row_mask:0xf bank_mask:0xf
    v_and_b32_dpp v23, v29, v11 row_ror:14 row_mask:0xf bank_mask:0xf
    v_mfma_f32_16x16x32_bf16 v[12:15], v[16:19], v[72:75], v[12:15]
    v_and_b32_dpp v16, v29, v8 row_ror:12 row_mask:0xf bank_mask:0xf
    v_and_b32_dpp v17, v29, v9 row_ror:14 row_mask:0xf bank_mask:0xf
    v_and_b32 v18, v29, v10
    v_and_b32_dpp v19, v29, v11 row_ror:2 row_mask:0xf bank_mask:0xf
    v_mfma_f32_16x16x32_bf16 v[12:15], v[20:23], v[76:79], v[12:15]
    v_and_b32_dpp v20, v29, v8 row_ror:4 row_mask:0xf bank_mask:0xf
    v_and_b32_dpp v21, v29, v9 row_ror:6 row_mask:0xf bank_mask:0xf
    v_and_b32_dpp v22, v29, v10 row_ror:8 row_mask:0xf bank_mask:0xf
    v_and_b32_dpp v23, v29, v11 row_ror:10 row_mask:0xf bank_mask:0xf
    v_mfma_f32_16x16x32_bf16 v[12:15], v[16:19], v[80:83], v[12:15]
    s_nop 0
    v_mfma_f32_16x16x32_bf16 v[12:15], v[20:23], v[84:87], v[12:15]
    s_cmp_eq_u32 s59, 8
    s_cbranch_scc0 L_vi0
    s_movk_i32 s39, 5120
    buffer_load_dwordx4 v[224:227], v248, s[52:55], s39 offen nt
    s_branch L_vc0
L_vi0:
    s_addk_i32 s57, 0x4000
    s_and_b32 s57, s57, s58
    s_cmp_lg_u32 s98, 0
    s_waitcnt vmcnt(7)
    s_cbranch_vccz L_dl3
    s_cbranch_scc1 L_dw3
    s_waitcnt vmcnt(5)
    s_branch L_dw3
L_dl3:
    s_waitcnt vmcnt(4)
    s_cbranch_scc0 L_dw3
    s_waitcnt vmcnt(3)
L_dw3:
    buffer_load_dwordx4 v[72:75], v1, s[40:43], s57 offen offset:0 nt
    s_waitcnt lgkmcnt(0)
    v_readfirstlane_b32 s5, v34
    v_readfirstlane_b32 s6, v35
    s_lshl_b32 s98, s96, 4
    s_sub_u32 s98, s98, s5
    s_mul_i32 s5, s6, s7
    s_sub_u32 s98, s98, s5
    s_add_u32 s7, s7, 1
    s_cmp_lg_u32 s6, 0
    s_cselect_b32 s98, s98, 0
    s_cmp_gt_i32 s98, 0
    s_cselect_b64 vcc, -1, 0
    s_add_u32 s98, s98, 960
    s_cmp_gt_u32 s98, 1760
    s_cselect_b32 s98, 1, 0
    s_waitcnt vmcnt(7)
    s_cbranch_vccz L_dl4
    s_cbranch_scc1 L_dw4
    s_waitcnt vmcnt(5)
    s_branch L_dw4
L_dl4:
    s_waitcnt vmcnt(4)
    s_cbranch_scc0 L_dw4
    s_waitcnt vmcnt(3)
L_dw4:
    buffer_load_dwordx4 v[76:79], v1, s[40:43], s57 offen offset:1024 nt
    s_waitcnt vmcnt(7)
    s_cbranch_vccz L_dl5
    s_cbranch_scc1 L_dw5
    s_waitcnt vmcnt(5)
    s_branch L_dw5
L_dl5:
    s_waitcnt vmcnt(4)
    s_cbranch_scc0 L_dw5
    s_waitcnt vmcnt(3)
L_dw5:
    buffer_load_dwordx4 v[80:83], v1, s[40:43], s57 offen offset:2048 nt
    s_waitcnt vmcnt(7)
    s_cbranch_vccz L_dl6
    s_cbranch_scc1 L_dw6
    s_waitcnt vmcnt(5)
    s_branch L_dw6
L_dl6:
    s_waitcnt vmcnt(4)
    s_cbranch_scc0 L_dw6
    s_waitcnt vmcnt(3)
L_dw6:
    buffer_load_dwordx4 v[84:87], v1, s[40:43], s57 offen offset:3072 nt
    ds_read_b128 v[32:35], v2
    s_memrealtime s[96:97]
L_vc0:
    v_subrev_f32 v28, s60, v41
    v_exp_f32 v28, v28
    v_mov_b32 v41, v49
    v_cvt_pk_bf16_f32 v29, v28, v28
    v_mov_b32 v49, v57
    v_mov_b32 v57, v65
    v_and_b32 v16, v29, v8
    v_and_b32_dpp v17, v29, v9 row_ror:2 row_mask:0xf bank_mask:0xf
    v_and_b32_dpp v18, v29, v10 row_ror:4 row_mask:0xf bank_mask:0xf
    v_and_b32_dpp v19, v29, v11 row_ror:6 row_mask:0xf bank_mask:0xf
    v_and_b32_dpp v20, v29, v8 row_ror:8 row_mask:0xf bank_mask:0xf
    v_and_b32_dpp v21, v29, v9 row_ror:10 row_mask:0xf bank_mask:0xf
    v_and_b32_dpp v22, v29, v10 row_ror:12 row_mask:0xf bank_mask:0xf
    v_and_b32_dpp v23, v29, v11 row_ror:14 row_mask:0xf bank_mask:0xf
    v_mfma_f32_16x16x32_bf16 v[12:15], v[16:19], v[88:91], v[12:15]
    v_and_b32_dpp v16, v29, v8 row_ror:12 row_mask:0xf bank_mask:0xf
    v_and_b32_dpp v17, v29, v9 row_ror:14 row_mask:0xf bank_mask:0xf
    v_and_b32 v18, v29, v10
    v_and_b32_dpp v19, v29, v11 row_ror:2 row_mask:0xf bank_mask:0xf
    v_mfma_f32_16x16x32_bf16 v[12:15], v[20:23], v[92:95], v[12:15]
    v_and_b32_dpp v20, v29, v8 row_ror:4 row_mask:0xf bank_mask:0xf
    v_and_b32_dpp v21, v29, v9 row_ror:6 row_mask:0xf bank_mask:0xf
    v_and_b32_dpp v22, v29, v10 row_ror:8 row_mask:0xf bank_mask:0xf
    v_and_b32_dpp v23, v29, v11 row_ror:10 row_mask:0xf bank_mask:0xf
    v_mfma_f32_16x16x32_bf16 v[12:15], v[16:19], v[96:99], v[12:15]
    s_nop 0
    v_mfma_f32_16x16x32_bf16 v[12:15], v[20:23], v[100:103], v[12:15]
    s_cmp_eq_u32 s59, 8
    s_cbranch_scc1 L_vc1
    s_addk_i32 s57, 0x4000
    s_and_b32 s57, s57, s58
    s_cmp_lg_u32 s98, 0
    s_waitcnt vmcnt(7)
    s_cbranch_vccz L_dl7
    s_cbranch_scc1 L_dw7
    s_waitcnt vmcnt(5)
    s_branch L_dw7
L_dl7:
    s_waitcnt vmcnt(4)
    s_cbranch_scc0 L_dw7
    s_waitcnt vmcnt(3)
L_dw7:
    buffer_load_dwordx4 v[88:91], v1, s[40:43], s57 offen offset:0 nt
    s_waitcnt lgkmcnt(0)
    v_readfirstlane_b32 s5, v34
    v_readfirstlane_b32 s6, v35
    s_lshl_b32 s98, s96, 4
    s_sub_u32 s98, s98, s5
    s_mul_i32 s5, s6, s7
    s_sub_u32 s98, s98, s5
    s_add_u32 s7, s7, 1
    s_cmp_lg_u32 s6, 0
    s_cselect_b32 s98, s98, 0
    s_cmp_gt_i32 s98, 0
    s_cselect_b64 vcc, -1, 0
    s_add_u32 s98, s98, 960
    s_cmp_gt_u32 s98, 1760
    s_cselect_b32 s98, 1, 0
    s_waitcnt vmcnt(7)
    s_cbranch_vccz L_dl8
    s_cbranch_scc1 L_dw8
    s_waitcnt vmcnt(5)
    s_branch L_dw8
L_dl8:
    s_waitcnt vmcnt(4)
    s_cbranch_scc0 L_dw8
    s_waitcnt vmcnt(3)
L_dw8:
    buffer_load_dwordx4 v[92:95], v1, s[40:43], s57 offen offset:1024 nt
    s_waitcnt vmcnt(7)
    s_cbranch_vccz L_dl9
    s_cbranch_scc1 L_dw9
    s_waitcnt vmcnt(5)
    s_branch L_dw9
L_dl9:
    s_waitcnt vmcnt(4)
    s_cbranch_scc0 L_dw9
    s_waitcnt vmcnt(3)
L_dw9:
    buffer_load_dwordx4 v[96:99], v1, s[40:43], s57 offen offset:2048 nt
    s_waitcnt vmcnt(7)
    s_cbranch_vccz L_dl10
    s_cbranch_scc1 L_dw10
    s_waitcnt vmcnt(5)
    s_branch L_dw10
L_dl10:
    s_waitcnt vmcnt(4)
    s_cbranch_scc0 L_dw10
    s_waitcnt vmcnt(3)
L_dw10:
    buffer_load_dwordx4 v[100:103], v1, s[40:43], s57 offen offset:3072 nt
    ds_read_b128 v[32:35], v2
    s_memrealtime s[96:97]
L_vc1:
    v_subrev_f32 v28, s60, v42
    v_exp_f32 v28, v28
    v_mov_b32 v42, v50
    v_cvt_pk_bf16_f32 v29, v28, v28
    v_mov_b32 v50, v58
    v_mov_b32 v58, v66
    v_and_b32 v16, v29, v8
    v_and_b32_dpp v17, v29, v9 row_ror:2 row_mask:0xf bank_mask:0xf
    v_and_b32_dpp v18, v29, v10 row_ror:4 row_mask:0xf bank_mask:0xf
    v_and_b32_dpp v19, v29, v11 row_ror:6 row_mask:0xf bank_mask:0xf
    v_and_b32_dpp v20, v29, v8 row_ror:8 row_mask:0xf bank_mask:0xf
    v_and_b32_dpp v21, v29, v9 row_ror:10 row_mask:0xf bank_mask:0xf
    v_and_b32_dpp v22, v29, v10 row_ror:12 row_mask:0xf bank_mask:0xf
    v_and_b32_dpp v23, v29, v11 row_ror:14 row_mask:0xf bank_mask:0xf
    v_mfma_f32_16x16x32_bf16 v[12:15], v[16:19], v[104:107], v[12:15]
    v_and_b32_dpp v16, v29, v8 row_ror:12 row_mask:0xf bank_mask:0xf
    v_and_b32_dpp v17, v29, v9 row_ror:14 row_mask:0xf bank_mask:0xf
    v_and_b32 v18, v29, v10
    v_and_b32_dpp v19, v29, v11 row_ror:2 row_mask:0xf bank_mask:0xf
    v_mfma_f32_16x16x32_bf16 v[12:15], v[20:23], v[108:111], v[12:15]
    v_and_b32_dpp v20, v29, v8 row_ror:4 row_mask:0xf bank_mask:0xf
    v_and_b32_dpp v21, v29, v9 row_ror:6 row_mask:0xf bank_mask:0xf
    v_and_b32_dpp v22, v29, v10 row_ror:8 row_mask:0xf bank_mask:0xf
    v_and_b32_dpp v23, v29, v11 row_ror:10 row_mask:0xf bank_mask:0xf
    v_mfma_f32_16x16x32_bf16 v[12:15], v[16:19], v[112:115], v[12:15]
    s_nop 0
    v_mfma_f32_16x16x32_bf16 v[12:15], v[20:23], v[116:119], v[12:15]
    s_cmp_eq_u32 s59, 8
    s_cbranch_scc0 L_vi2
    s_movk_i32 s39, 6400
    buffer_load_dwordx4 v[228:231], v248, s[52:55], s39 offen nt
    s_branch L_vc2
L_vi2:
    s_addk_i32 s57, 0x4000
    s_and_b32 s57, s57, s58
    s_cmp_lg_u32 s98, 0
    s_waitcnt vmcnt(7)
    s_cbranch_vccz L_dl11
    s_cbranch_scc1 L_dw11
    s_waitcnt vmcnt(5)
    s_branch L_dw11
L_dl11:
    s_waitcnt vmcnt(4)
    s_cbranch_scc0 L_dw11
    s_waitcnt vmcnt(3)
L_dw11:
    buffer_load_dwordx4 v[104:107], v1, s[40:43], s57 offen offset:0 nt
    s_waitcnt lgkmcnt(0)
    v_readfirstlane_b32 s5, v34
    v_readfirstlane_b32 s6, v35
    s_lshl_b32 s98, s96, 4
    s_sub_u32 s98, s98, s5
    s_mul_i32 s5, s6, s7
    s_sub_u32 s98, s98, s5
    s_add_u32 s7, s7, 1
    s_cmp_lg_u32 s6, 0
    s_cselect_b32 s98, s98, 0
    s_cmp_gt_i32 s98, 0
    s_cselect_b64 vcc, -1, 0
    s_add_u32 s98, s98, 960
    s_cmp_gt_u32 s98, 1760
    s_cselect_b32 s98, 1, 0
    s_waitcnt vmcnt(7)
    s_cbranch_vccz L_dl12
    s_cbranch_scc1 L_dw12
    s_waitcnt vmcnt(5)
    s_branch L_dw12
L_dl12:
    s_waitcnt vmcnt(4)
    s_cbranch_scc0 L_dw12
    s_waitcnt vmcnt(3)
L_dw12:
    buffer_load_dwordx4 v[108:111], v1, s[40:43], s57 offen offset:1024 nt
    s_waitcnt vmcnt(7)
    s_cbranch_vccz L_dl13
    s_cbranch_scc1 L_dw13
    s_waitcnt vmcnt(5)
    s_branch L_dw13
L_dl13:
    s_waitcnt vmcnt(4)
    s_cbranch_scc0 L_dw13
    s_waitcnt vmcnt(3)
L_dw13:
    buffer_load_dwordx4 v[112:115], v1, s[40:43], s57 offen offset:2048 nt
    s_waitcnt vmcnt(7)
    s_cbranch_vccz L_dl14
    s_cbranch_scc1 L_dw14
    s_waitcnt vmcnt(5)
    s_branch L_dw14
L_dl14:
    s_waitcnt vmcnt(4)
    s_cbranch_scc0 L_dw14
    s_waitcnt vmcnt(3)
L_dw14:
    buffer_load_dwordx4 v[116:119], v1, s[40:43], s57 offen offset:3072 nt
    ds_read_b128 v[32:35], v2
    s_memrealtime s[96:97]
L_vc2:
    v_subrev_f32 v28, s60, v43
    v_exp_f32 v28, v28
    v_mov_b32 v43, v51
    v_cvt_pk_bf16_f32 v29, v28, v28
    v_mov_b32 v51, v59
    v_mov_b32 v59, v67
    v_and_b32 v16, v29, v8
    v_and_b32_dpp v17, v29, v9 row_ror:2 row_mask:0xf bank_mask:0xf
    v_and_b32_dpp v18, v29, v10 row_ror:4 row_mask:0xf bank_mask:0xf
    v_and_b32_dpp v19, v29, v11 row_ror:6 row_mask:0xf bank_mask:0xf
    v_and_b32_dpp v20, v29, v8 row_ror:8 row_mask:0xf bank_mask:0xf
    v_and_b32_dpp v21, v29, v9 row_ror:10 row_mask:0xf bank_mask:0xf
    v_and_b32_dpp v22, v29, v10 row_ror:12 row_mask:0xf bank_mask:0xf
    v_and_b32_dpp v23, v29, v11 row_ror:14 row_mask:0xf bank_mask:0xf
    v_mfma_f32_16x16x32_bf16 v[12:15], v[16:19], v[120:123], v[12:15]
    v_and_b32_dpp v16, v29, v8 row_ror:12 row_mask:0xf bank_mask:0xf
    v_and_b32_dpp v17, v29, v9 row_ror:14 row_mask:0xf bank_mask:0xf
    v_and_b32 v18, v29, v10
    v_and_b32_dpp v19, v29, v11 row_ror:2 row_mask:0xf bank_mask:0xf
    v_mfma_f32_16x16x32_bf16 v[12:15], v[20:23], v[124:127], v[12:15]
    v_and_b32_dpp v20, v29, v8 row_ror:4 row_mask:0xf bank_mask:0xf
    v_and_b32_dpp v21, v29, v9 row_ror:6 row_mask:0xf bank_mask:0xf
    v_and_b32_dpp v22, v29, v10 row_ror:8 row_mask:0xf bank_mask:0xf
    v_and_b32_dpp v23, v29, v11 row_ror:10 row_mask:0xf bank_mask:0xf
    v_mfma_f32_16x16x32_bf16 v[12:15], v[16:19], v[128:131], v[12:15]
    s_nop 0
    v_mfma_f32_16x16x32_bf16 v[12:15], v[20:23], v[132:135], v[12:15]
    s_cmp_eq_u32 s59, 8
    s_cbranch_scc1 L_vc3
    s_addk_i32 s57, 0x4000
    s_and_b32 s57, s57, s58
    s_cmp_lg_u32 s98, 0
    s_waitcnt vmcnt(7)
    s_cbranch_vccz L_dl15
    s_cbranch_scc1 L_dw15
    s_waitcnt vmcnt(5)
    s_branch L_dw15
L_dl15:
    s_waitcnt vmcnt(4)
    s_cbranch_scc0 L_dw15
    s_waitcnt vmcnt(3)
L_dw15:
    buffer_load_dwordx4 v[120:123], v1, s[40:43], s57 offen offset:0 nt
    s_waitcnt lgkmcnt(0)
    v_readfirstlane_b32 s5, v34
    v_readfirstlane_b32 s6, v35
    s_lshl_b32 s98, s96, 4
    s_sub_u32 s98, s98, s5
    s_mul_i32 s5, s6, s7
    s_sub_u32 s98, s98, s5
    s_add_u32 s7, s7, 1
    s_cmp_lg_u32 s6, 0
    s_cselect_b32 s98, s98, 0
    s_cmp_gt_i32 s98, 0
    s_cselect_b64 vcc, -1, 0
    s_add_u32 s98, s98, 960
    s_cmp_gt_u32 s98, 1760
    s_cselect_b32 s98, 1, 0
    s_waitcnt vmcnt(7)
    s_cbranch_vccz L_dl16
    s_cbranch_scc1 L_dw16
    s_waitcnt vmcnt(5)
    s_branch L_dw16
L_dl16:
    s_waitcnt vmcnt(4)
    s_cbranch_scc0 L_dw16
    s_waitcnt vmcnt(3)
L_dw16:
    buffer_load_dwordx4 v[124:127], v1, s[40:43], s57 offen offset:1024 nt
    s_waitcnt vmcnt(7)
    s_cbranch_vccz L_dl17
    s_cbranch_scc1 L_dw17
    s_waitcnt vmcnt(5)
    s_branch L_dw17
L_dl17:
    s_waitcnt vmcnt(4)
    s_cbranch_scc0 L_dw17
    s_waitcnt vmcnt(3)
L_dw17:
    buffer_load_dwordx4 v[128:131], v1, s[40:43], s57 offen offset:2048 nt
    s_waitcnt vmcnt(7)
    s_cbranch_vccz L_dl18
    s_cbranch_scc1 L_dw18
    s_waitcnt vmcnt(5)
    s_branch L_dw18
L_dl18:
    s_waitcnt vmcnt(4)
    s_cbranch_scc0 L_dw18
    s_waitcnt vmcnt(3)
L_dw18:
    buffer_load_dwordx4 v[132:135], v1, s[40:43], s57 offen offset:3072 nt
    ds_read_b128 v[32:35], v2
    s_memrealtime s[96:97]
L_vc3:
    v_subrev_f32 v28, s60, v44
    v_exp_f32 v28, v28
    v_mov_b32 v44, v52
    v_cvt_pk_bf16_f32 v29, v28, v28
    v_mov_b32 v52, v60
    v_mov_b32 v60, v68
    v_and_b32 v16, v29, v8
    v_and_b32_dpp v17, v29, v9 row_ror:2 row_mask:0xf bank_mask:0xf
    v_and_b32_dpp v18, v29, v10 row_ror:4 row_mask:0xf bank_mask:0xf
    v_and_b32_dpp v19, v29, v11 row_ror:6 row_mask:0xf bank_mask:0xf
    v_and_b32_dpp v20, v29, v8 row_ror:8 row_mask:0xf bank_mask:0xf
    v_and_b32_dpp v21, v29, v9 row_ror:10 row_mask:0xf bank_mask:0xf
    v_and_b32_dpp v22, v29, v10 row_ror:12 row_mask:0xf bank_mask:0xf
    v_and_b32_dpp v23, v29, v11 row_ror:14 row_mask:0xf bank_mask:0xf
    v_mfma_f32_16x16x32_bf16 v[12:15], v[16:19], v[136:139], v[12:15]
    v_and_b32_dpp v16, v29, v8 row_ror:12 row_mask:0xf bank_mask:0xf
    v_and_b32_dpp v17, v29, v9 row_ror:14 row_mask:0xf bank_mask:0xf
    v_and_b32 v18, v29, v10
    v_and_b32_dpp v19, v29, v11 row_ror:2 row_mask:0xf bank_mask:0xf
    v_mfma_f32_16x16x32_bf16 v[12:15], v[20:23], v[140:143], v[12:15]
    v_and_b32_dpp v20, v29, v8 row_ror:4 row_mask:0xf bank_mask:0xf
    v_and_b32_dpp v21, v29, v9 row_ror:6 row_mask:0xf bank_mask:0xf
    v_and_b32_dpp v22, v29, v10 row_ror:8 row_mask:0xf bank_mask:0xf
    v_and_b32_dpp v23, v29, v11 row_ror:10 row_mask:0xf bank_mask:0xf
    v_mfma_f32_16x16x32_bf16 v[12:15], v[16:19], v[144:147], v[12:15]
    s_nop 0
    v_mfma_f32_16x16x32_bf16 v[12:15], v[20:23], v[148:151], v[12:15]
    s_cmp_eq_u32 s59, 8
    s_cbranch_scc0 L_vi4
    s_movk_i32 s39, 7680
    buffer_load_dwordx4 v[232:235], v248, s[52:55], s39 offen nt
    s_branch L_vc4
L_vi4:
    s_addk_i32 s57, 0x4000
    s_and_b32 s57, s57, s58
    s_cmp_lg_u32 s98, 0
    s_waitcnt vmcnt(7)
    s_cbranch_vccz L_dl19
    s_cbranch_scc1 L_dw19
    s_waitcnt vmcnt(5)
    s_branch L_dw19
L_dl19:
    s_waitcnt vmcnt(4)
    s_cbranch_scc0 L_dw19
    s_waitcnt vmcnt(3)
L_dw19:
    buffer_load_dwordx4 v[136:139], v1, s[40:43], s57 offen offset:0 nt
    s_waitcnt lgkmcnt(0)
    v_readfirstlane_b32 s5, v34
    v_readfirstlane_b32 s6, v35
    s_lshl_b32 s98, s96, 4
    s_sub_u32 s98, s98, s5
    s_mul_i32 s5, s6, s7
    s_sub_u32 s98, s98, s5
    s_add_u32 s7, s7, 1
    s_cmp_lg_u32 s6, 0
    s_cselect_b32 s98, s98, 0
    s_cmp_gt_i32 s98, 0
    s_cselect_b64 vcc, -1, 0
    s_add_u32 s98, s98, 960
    s_cmp_gt_u32 s98, 1760
    s_cselect_b32 s98, 1, 0
    s_waitcnt vmcnt(7)
    s_cbranch_vccz L_dl20
    s_cbranch_scc1 L_dw20
    s_waitcnt vmcnt(5)
    s_branch L_dw20
L_dl20:
    s_waitcnt vmcnt(4)
    s_cbranch_scc0 L_dw20
    s_waitcnt vmcnt(3)
L_dw20:
    buffer_load_dwordx4 v[140:143], v1, s[40:43], s57 offen offset:1024 nt
    s_waitcnt vmcnt(7)
    s_cbranch_vccz L_dl21
    s_cbranch_scc1 L_dw21
    s_waitcnt vmcnt(5)
    s_branch L_dw21
L_dl21:
    s_waitcnt vmcnt(4)
    s_cbranch_scc0 L_dw21
    s_waitcnt vmcnt(3)
L_dw21:
    buffer_load_dwordx4 v[144:147], v1, s[40:43], s57 offen offset:2048 nt
    s_waitcnt vmcnt(7)
    s_cbranch_vccz L_dl22
    s_cbranch_scc1 L_dw22
    s_waitcnt vmcnt(5)
    s_branch L_dw22
L_dl22:
    s_waitcnt vmcnt(4)
    s_cbranch_scc0 L_dw22
    s_waitcnt vmcnt(3)
L_dw22:
    buffer_load_dwordx4 v[148:151], v1, s[40:43], s57 offen offset:3072 nt
    ds_read_b128 v[32:35], v2
    s_memrealtime s[96:97]
L_vc4:
    v_subrev_f32 v28, s60, v45
    v_exp_f32 v28, v28
    v_mov_b32 v45, v53
    v_cvt_pk_bf16_f32 v29, v28, v28
    v_mov_b32 v53, v61
    v_mov_b32 v61, v69
    v_and_b32 v16, v29, v8
    v_and_b32_dpp v17, v29, v9 row_ror:2 row_mask:0xf bank_mask:0xf
    v_and_b32_dpp v18, v29, v10 row_ror:4 row_mask:0xf bank_mask:0xf
    v_and_b32_dpp v19, v29, v11 row_ror:6 row_mask:0xf bank_mask:0xf
    v_and_b32_dpp v20, v29, v8 row_ror:8 row_mask:0xf bank_mask:0xf
    v_and_b32_dpp v21, v29, v9 row_ror:10 row_mask:0xf bank_mask:0xf
    v_and_b32_dpp v22, v29, v10 row_ror:12 row_mask:0xf bank_mask:0xf
    v_and_b32_dpp v23, v29, v11 row_ror:14 row_mask:0xf bank_mask:0xf
    v_mfma_f32_16x16x32_bf16 v[12:15], v[16:19], v[152:155], v[12:15]
    v_and_b32_dpp v16, v29, v8 row_ror:12 row_mask:0xf bank_mask:0xf
    v_and_b32_dpp v17, v29, v9 row_ror:14 row_mask:0xf bank_mask:0xf
    v_and_b32 v18, v29, v10
    v_and_b32_dpp v19, v29, v11 row_ror:2 row_mask:0xf bank_mask:0xf
    v_mfma_f32_16x16x32_bf16 v[12:15], v[20:23], v[156:159], v[12:15]
    v_and_b32_dpp v20, v29, v8 row_ror:4 row_mask:0xf bank_mask:0xf
    v_and_b32_dpp v21, v29, v9 row_ror:6 row_mask:0xf bank_mask:0xf
    v_and_b32_dpp v22, v29, v10 row_ror:8 row_mask:0xf bank_mask:0xf
    v_and_b32_dpp v23, v29, v11 row_ror:10 row_mask:0xf bank_mask:0xf
    v_mfma_f32_16x16x32_bf16 v[12:15], v[16:19], v[160:163], v[12:15]
    s_nop 0
    v_mfma_f32_16x16x32_bf16 v[12:15], v[20:23], v[164:167], v[12:15]
    s_cmp_eq_u32 s59, 8
    s_cbranch_scc0 L_vi5
    s_movk_i32 s39, 8960
    buffer_load_dwordx4 v[236:239], v248, s[52:55], s39 offen nt
    s_waitcnt vmcnt(12)
    s_branch L_vc5
L_vi5:
    s_addk_i32 s57, 0x4000
    s_and_b32 s57, s57, s58
    s_cmp_lg_u32 s98, 0
    s_waitcnt vmcnt(7)
    s_cbranch_vccz L_dl23
    s_cbranch_scc1 L_dw23
    s_waitcnt vmcnt(5)
    s_branch L_dw23
L_dl23:
    s_waitcnt vmcnt(4)
    s_cbranch_scc0 L_dw23
    s_waitcnt vmcnt(3)
L_dw23:
    buffer_load_dwordx4 v[152:155], v1, s[40:43], s57 offen offset:0 nt
    s_waitcnt lgkmcnt(0)
    v_readfirstlane_b32 s5, v34
    v_readfirstlane_b32 s6, v35
    s_lshl_b32 s98, s96, 4
    s_sub_u32 s98, s98, s5
    s_mul_i32 s5, s6, s7
    s_sub_u32 s98, s98, s5
    s_add_u32 s7, s7, 1
    s_cmp_lg_u32 s6, 0
    s_cselect_b32 s98, s98, 0
    s_cmp_gt_i32 s98, 0
    s_cselect_b64 vcc, -1, 0
    s_add_u32 s98, s98, 960
    s_cmp_gt_u32 s98, 1760
    s_cselect_b32 s98, 1, 0
    s_waitcnt vmcnt(7)
    s_cbranch_vccz L_dl24
    s_cbranch_scc1 L_dw24
    s_waitcnt vmcnt(5)
    s_branch L_dw24
L_dl24:
    s_waitcnt vmcnt(4)
    s_cbranch_scc0 L_dw24
    s_waitcnt vmcnt(3)
L_dw24:
    buffer_load_dwordx4 v[156:159], v1, s[40:43], s57 offen offset:1024 nt
    s_waitcnt vmcnt(7)
    s_cbranch_vccz L_dl25
    s_cbranch_scc1 L_dw25
    s_waitcnt vmcnt(5)
    s_branch L_dw25
L_dl25:
    s_waitcnt vmcnt(4)
    s_cbranch_scc0 L_dw25
    s_waitcnt vmcnt(3)
L_dw25:
    buffer_load_dwordx4 v[160:163], v1, s[40:43], s57 offen offset:2048 nt
    s_waitcnt vmcnt(7)
    s_cbranch_vccz L_dl26
    s_cbranch_scc1 L_dw26
    s_waitcnt vmcnt(5)
    s_branch L_dw26
L_dl26:
    s_waitcnt vmcnt(4)
    s_cbranch_scc0 L_dw26
    s_waitcnt vmcnt(3)
L_dw26:
    buffer_load_dwordx4 v[164:167], v1, s[40:43], s57 offen offset:3072 nt
    ds_read_b128 v[32:35], v2
    s_memrealtime s[96:97]
L_vc5:
    v_subrev_f32 v28, s60, v46
    v_exp_f32 v28, v28
    v_mov_b32 v46, v54
    v_cvt_pk_bf16_f32 v29, v28, v28
    v_mov_b32 v54, v62
    v_mov_b32 v62, v70
    v_and_b32 v16, v29, v8
    v_and_b32_dpp v17, v29, v9 row_ror:2 row_mask:0xf bank_mask:0xf
    v_and_b32_dpp v18, v29, v10 row_ror:4 row_mask:0xf bank_mask:0xf
    v_and_b32_dpp v19, v29, v11 row_ror:6 row_mask:0xf bank_mask:0xf
    v_and_b32_dpp v20, v29, v8 row_ror:8 row_mask:0xf bank_mask:0xf
    v_and_b32_dpp v21, v29, v9 row_ror:10 row_mask:0xf bank_mask:0xf
    v_and_b32_dpp v22, v29, v10 row_ror:12 row_mask:0xf bank_mask:0xf
    v_and_b32_dpp v23, v29, v11 row_ror:14 row_mask:0xf bank_mask:0xf
    v_mfma_f32_16x16x32_bf16 v[12:15], v[16:19], v[168:171], v[12:15]
    v_and_b32_dpp v16, v29, v8 row_ror:12 row_mask:0xf bank_mask:0xf
    v_and_b32_dpp v17, v29, v9 row_ror:14 row_mask:0xf bank_mask:0xf
    v_and_b32 v18, v29, v10
    v_and_b32_dpp v19, v29, v11 row_ror:2 row_mask:0xf bank_mask:0xf
    v_mfma_f32_16x16x32_bf16 v[12:15], v[20:23], v[172:175], v[12:15]
    v_and_b32_dpp v20, v29, v8 row_ror:4 row_mask:0xf bank_mask:0xf
    v_and_b32_dpp v21, v29, v9 row_ror:6 row_mask:0xf bank_mask:0xf
    v_and_b32_dpp v22, v29, v10 row_ror:8 row_mask:0xf bank_mask:0xf
    v_and_b32_dpp v23, v29, v11 row_ror:10 row_mask:0xf bank_mask:0xf
    v_mfma_f32_16x16x32_bf16 v[12:15], v[16:19], v[176:179], v[12:15]
    s_nop 0
    v_mfma_f32_16x16x32_bf16 v[12:15], v[20:23], v[180:183], v[12:15]
    s_cmp_eq_u32 s59, 8
    s_cbranch_scc0 L_vi6
    s_branch L_last
L_vi6:
    s_addk_i32 s57, 0x4000
    s_and_b32 s57, s57, s58
    s_cmp_lg_u32 s98, 0
    s_waitcnt vmcnt(7)
    s_cbranch_vccz L_dl27
    s_cbranch_scc1 L_dw27
    s_waitcnt vmcnt(5)
    s_branch L_dw27
L_dl27:
    s_waitcnt vmcnt(4)
    s_cbranch_scc0 L_dw27
    s_waitcnt vmcnt(3)
L_dw27:
    buffer_load_dwordx4 v[168:171], v1, s[40:43], s57 offen offset:0 nt
    s_waitcnt lgkmcnt(0)
    v_readfirstlane_b32 s5, v34
    v_readfirstlane_b32 s6, v35
    s_lshl_b32 s98, s96, 4
    s_sub_u32 s98, s98, s5
    s_mul_i32 s5, s6, s7
    s_sub_u32 s98, s98, s5
    s_add_u32 s7, s7, 1
    s_cmp_lg_u32 s6, 0
    s_cselect_b32 s98, s98, 0
    s_cmp_gt_i32 s98, 0
    s_cselect_b64 vcc, -1, 0
    s_add_u32 s98, s98, 960
    s_cmp_gt_u32 s98, 1760
    s_cselect_b32 s98, 1, 0
    s_waitcnt vmcnt(7)
    s_cbranch_vccz L_dl28
    s_cbranch_scc1 L_dw28
    s_waitcnt vmcnt(5)
    s_branch L_dw28
L_dl28:
    s_waitcnt vmcnt(4)
    s_cbranch_scc0 L_dw28
    s_waitcnt vmcnt(3)
L_dw28:
    buffer_load_dwordx4 v[172:175], v1, s[40:43], s57 offen offset:1024 nt
    s_waitcnt vmcnt(7)
    s_cbranch_vccz L_dl29
    s_cbranch_scc1 L_dw29
    s_waitcnt vmcnt(5)
    s_branch L_dw29
L_dl29:
    s_waitcnt vmcnt(4)
    s_cbranch_scc0 L_dw29
    s_waitcnt vmcnt(3)
L_dw29:
    buffer_load_dwordx4 v[176:179], v1, s[40:43], s57 offen offset:2048 nt
    s_waitcnt vmcnt(7)
    s_cbranch_vccz L_dl30
    s_cbranch_scc1 L_dw30
    s_waitcnt vmcnt(5)
    s_branch L_dw30
L_dl30:
    s_waitcnt vmcnt(4)
    s_cbranch_scc0 L_dw30
    s_waitcnt vmcnt(3)
L_dw30:
    buffer_load_dwordx4 v[180:183], v1, s[40:43], s57 offen offset:3072 nt
    ds_read_b128 v[32:35], v2
    s_memrealtime s[96:97]
L_vc6:
    v_subrev_f32 v28, s60, v47
    v_exp_f32 v28, v28
    v_mov_b32 v47, v55
    v_cvt_pk_bf16_f32 v29, v28, v28
    v_mov_b32 v55, v63
    v_mov_b32 v63, v71
    v_and_b32 v16, v29, v8
    v_and_b32_dpp v17, v29, v9 row_ror:2 row_mask:0xf bank_mask:0xf
    v_and_b32_dpp v18, v29, v10 row_ror:4 row_mask:0xf bank_mask:0xf
    v_and_b32_dpp v19, v29, v11 row_ror:6 row_mask:0xf bank_mask:0xf
    v_and_b32_dpp v20, v29, v8 row_ror:8 row_mask:0xf bank_mask:0xf
    v_and_b32_dpp v21, v29, v9 row_ror:10 row_mask:0xf bank_mask:0xf
    v_and_b32_dpp v22, v29, v10 row_ror:12 row_mask:0xf bank_mask:0xf
    v_and_b32_dpp v23, v29, v11 row_ror:14 row_mask:0xf bank_mask:0xf
    v_mfma_f32_16x16x32_bf16 v[12:15], v[16:19], v[184:187], v[12:15]
    v_and_b32_dpp v16, v29, v8 row_ror:12 row_mask:0xf bank_mask:0xf
    v_and_b32_dpp v17, v29, v9 row_ror:14 row_mask:0xf bank_mask:0xf
    v_and_b32 v18, v29, v10
    v_and_b32_dpp v19, v29, v11 row_ror:2 row_mask:0xf bank_mask:0xf
    v_mfma_f32_16x16x32_bf16 v[12:15], v[20:23], v[188:191], v[12:15]
    v_and_b32_dpp v20, v29, v8 row_ror:4 row_mask:0xf bank_mask:0xf
    v_and_b32_dpp v21, v29, v9 row_ror:6 row_mask:0xf bank_mask:0xf
    v_and_b32_dpp v22, v29, v10 row_ror:8 row_mask:0xf bank_mask:0xf
    v_and_b32_dpp v23, v29, v11 row_ror:10 row_mask:0xf bank_mask:0xf
    v_mfma_f32_16x16x32_bf16 v[12:15], v[16:19], v[192:195], v[12:15]
    s_nop 0
    v_mfma_f32_16x16x32_bf16 v[12:15], v[20:23], v[196:199], v[12:15]
    s_cmp_eq_u32 s59, 8
    s_cbranch_scc1 L_vc7
    s_addk_i32 s57, 0x4000
    s_and_b32 s57, s57, s58
    s_cmp_lg_u32 s98, 0
    s_waitcnt vmcnt(7)
    s_cbranch_vccz L_dl31
    s_cbranch_scc1 L_dw31
    s_waitcnt vmcnt(5)
    s_branch L_dw31
L_dl31:
    s_waitcnt vmcnt(4)
    s_cbranch_scc0 L_dw31
    s_waitcnt vmcnt(3)
L_dw31:
    buffer_load_dwordx4 v[184:187], v1, s[40:43], s57 offen offset:0 nt
    s_waitcnt lgkmcnt(0)
    v_readfirstlane_b32 s5, v34
    v_readfirstlane_b32 s6, v35
    s_lshl_b32 s98, s96, 4
    s_sub_u32 s98, s98, s5
    s_mul_i32 s5, s6, s7
    s_sub_u32 s98, s98, s5
    s_add_u32 s7, s7, 1
    s_cmp_lg_u32 s6, 0
    s_cselect_b32 s98, s98, 0
    s_cmp_gt_i32 s98, 0
    s_cselect_b64 vcc, -1, 0
    s_add_u32 s98, s98, 960
    s_cmp_gt_u32 s98, 1760
    s_cselect_b32 s98, 1, 0
    s_waitcnt vmcnt(7)
    s_cbranch_vccz L_dl32
    s_cbranch_scc1 L_dw32
    s_waitcnt vmcnt(5)
    s_branch L_dw32
L_dl32:
    s_waitcnt vmcnt(4)
    s_cbranch_scc0 L_dw32
    s_waitcnt vmcnt(3)
L_dw32:
    buffer_load_dwordx4 v[188:191], v1, s[40:43], s57 offen offset:1024 nt
    s_waitcnt vmcnt(7)
    s_cbranch_vccz L_dl33
    s_cbranch_scc1 L_dw33
    s_waitcnt vmcnt(5)
    s_branch L_dw33
L_dl33:
    s_waitcnt vmcnt(4)
    s_cbranch_scc0 L_dw33
    s_waitcnt vmcnt(3)
L_dw33:
    buffer_load_dwordx4 v[192:195], v1, s[40:43], s57 offen offset:2048 nt
    s_waitcnt vmcnt(7)
    s_cbranch_vccz L_dl34
    s_cbranch_scc1 L_dw34
    s_waitcnt vmcnt(5)
    s_branch L_dw34
L_dl34:
    s_waitcnt vmcnt(4)
    s_cbranch_scc0 L_dw34
    s_waitcnt vmcnt(3)
L_dw34:
    buffer_load_dwordx4 v[196:199], v1, s[40:43], s57 offen offset:3072 nt
    ds_read_b128 v[32:35], v2
    s_memrealtime s[96:97]
    s_branch L_vloop
L_last:
    v_subrev_f32 v28, s60, v47
    v_exp_f32 v28, v28
    s_nop 0
    v_cvt_pk_bf16_f32 v29, v28, v28
    v_and_b32 v72, v29, v8
    s_nop 0
    v_and_b32_dpp v73, v29, v9 row_ror:2 row_mask:0xf bank_mask:0xf
    v_and_b32_dpp v74, v29, v10 row_ror:4 row_mask:0xf bank_mask:0xf
    v_and_b32_dpp v75, v29, v11 row_ror:6 row_mask:0xf bank_mask:0xf
    v_and_b32_dpp v76, v29, v8 row_ror:8 row_mask:0xf bank_mask:0xf
    v_and_b32_dpp v77, v29, v9 row_ror:10 row_mask:0xf bank_mask:0xf
    v_and_b32_dpp v78, v29, v10 row_ror:12 row_mask:0xf bank_mask:0xf
    v_and_b32_dpp v79, v29, v11 row_ror:14 row_mask:0xf bank_mask:0xf
    v_and_b32_dpp v80, v29, v8 row_ror:12 row_mask:0xf bank_mask:0xf
    v_and_b32_dpp v81, v29, v9 row_ror:14 row_mask:0xf bank_mask:0xf
    v_and_b32 v82, v29, v10
    v_and_b32_dpp v83, v29, v11 row_ror:2 row_mask:0xf bank_mask:0xf
    v_and_b32_dpp v84, v29, v8 row_ror:4 row_mask:0xf bank_mask:0xf
    v_and_b32_dpp v85, v29, v9 row_ror:6 row_mask:0xf bank_mask:0xf
    v_and_b32_dpp v86, v29, v10 row_ror:8 row_mask:0xf bank_mask:0xf
    v_and_b32_dpp v87, v29, v11 row_ror:10 row_mask:0xf bank_mask:0xf
    s_waitcnt lgkmcnt(0)
    s_waitcnt vmcnt(11)
    v_mfma_f32_16x16x32_bf16 v[12:15], v[72:75], v[184:187], v[12:15]
    s_waitcnt vmcnt(10)
    v_mfma_f32_16x16x32_bf16 v[12:15], v[76:79], v[188:191], v[12:15]
    s_waitcnt vmcnt(9)
    v_mfma_f32_16x16x32_bf16 v[12:15], v[80:83], v[192:195], v[12:15]
    s_waitcnt vmcnt(8)
    v_mfma_f32_16x16x32_bf16 v[12:15], v[84:87], v[196:199], v[12:15]
    s_nop 1
L_vc7:
    s_waitcnt lgkmcnt(0)
    s_nop 4
    v_mul_f32 v16, v36, v12
    v_mul_f32 v17, v36, v13
    v_mul_f32 v18, v36, v14
    v_mul_f32 v19, v36, v15
    ds_write_b128 v250, v[16:19] offset:512
    s_mov_b64 exec, 1
    ds_add_rtn_u32 v37, v2, v251 offset:20
    s_mov_b64 exec, -1
    ds_read_b128 v[72:75], v1 offset:512
    ds_read_b128 v[76:79], v1 offset:1536
    ds_read_b128 v[80:83], v1 offset:2560
    ds_read_b128 v[84:87], v1 offset:3584
    s_waitcnt lgkmcnt(4)
    v_readfirstlane_b32 s39, v37
    s_cmp_lg_u32 s39, 3
    s_cbranch_scc1 L_owait
    s_waitcnt lgkmcnt(2)
    v_add_f32 v72, v72, v76
    v_add_f32 v73, v73, v77
    v_add_f32 v74, v74, v78
    v_add_f32 v75, v75, v79
    s_waitcnt lgkmcnt(0)
    v_add_f32 v80, v80, v84
    v_add_f32 v81, v81, v85
    v_add_f32 v82, v82, v86
    v_add_f32 v83, v83, v87
    v_add_f32 v72, v72, v80
    v_add_f32 v73, v73, v81
    v_add_f32 v74, v74, v82
    v_add_f32 v75, v75, v83
    v_bfi_b32 v72, v204, v200, v72
    v_bfi_b32 v73, v204, v201, v73
    v_bfi_b32 v74, v204, v202, v74
    v_bfi_b32 v75, v204, v203, v75
    s_cmp_eq_u32 s46, 1
    s_cbranch_scc1 L_ofast
    buffer_store_dwordx4 v[72:75], v38, s[48:51], s66 offen sc1
    s_branch L_opoll
L_ofast:
    buffer_store_dwordx4 v[72:75], v38, s[48:51], s66 offen
    s_branch L_opoll
L_owait:
    s_mov_b32 s67, 1048576
    v_mov_b32 v24, 276
L_pw35:
    ds_read_b32 v25, v24
    s_waitcnt lgkmcnt(0)
    v_readfirstlane_b32 s39, v25
    s_cmp_ge_u32 s39, 4
    s_cbranch_scc1 L_pd35
    s_sub_u32 s67, s67, 1
    s_cmp_lg_u32 s67, 0
    s_cbranch_scc1 L_pw35
L_pd35:
L_opoll:
    s_mov_b32 s67, 131072
L_gw36:
    buffer_load_dwordx4 v[88:91], v1, s[48:51], s47 offen sc1
    s_waitcnt vmcnt(0)
    v_xor_b32 v88, s70, v88
    v_xor_b32 v89, s71, v89
    v_xor_b32 v90, s72, v90
    v_xor_b32 v91, s73, v91
    v_or3_b32 v24, v88, v89, v90
    v_or_b32 v24, v24, v91
    v_and_b32 v24, 0xfff, v24
    v_cmp_ne_u32 vcc, 0, v24
    s_nop 1
    s_cmp_eq_u64 vcc, 0
    s_cbranch_scc1 L_gd36
    s_sub_u32 s67, s67, 1
    s_cmp_lg_u32 s67, 0
    s_cbranch_scc1 L_gw36
L_gd36:
    v_add_f32_dpp v92, v88, v88 quad_perm:[1,0,3,2] row_mask:0xf bank_mask:0xf
    v_add_f32_dpp v93, v89, v89 quad_perm:[1,0,3,2] row_mask:0xf bank_mask:0xf
    v_add_f32_dpp v94, v90, v90 quad_perm:[1,0,3,2] row_mask:0xf bank_mask:0xf
    v_add_f32_dpp v95, v91, v91 quad_perm:[1,0,3,2] row_mask:0xf bank_mask:0xf
    v_add_f32_dpp v88, v92, v92 quad_perm:[2,3,0,1] row_mask:0xf bank_mask:0xf
    v_add_f32_dpp v89, v93, v93 quad_perm:[2,3,0,1] row_mask:0xf bank_mask:0xf
    v_add_f32_dpp v90, v94, v94 quad_perm:[2,3,0,1] row_mask:0xf bank_mask:0xf
    v_add_f32_dpp v91, v95, v95 quad_perm:[2,3,0,1] row_mask:0xf bank_mask:0xf
    v_cvt_pk_bf16_f32 v96, v88, v89
    v_cvt_pk_bf16_f32 v97, v90, v91
    v_cvt_pk_bf16_f32 v98, v88, v89
    v_cvt_pk_bf16_f32 v99, v90, v91
    v_cvt_pk_bf16_f32 v100, v88, v89
    v_cvt_pk_bf16_f32 v101, v90, v91
    s_nop 0
    v_mov_b32_dpp v96, v100 row_half_mirror row_mask:0xf bank_mask:0xa
    v_mov_b32_dpp v97, v101 row_half_mirror row_mask:0xf bank_mask:0xa
    v_mov_b32_dpp v98, v100 row_half_mirror row_mask:0xf bank_mask:0x5
    v_mov_b32_dpp v99, v101 row_half_mirror row_mask:0xf bank_mask:0x5
    v_perm_b32 v16, v96, v96, v240
    v_perm_b32 v17, v96, v96, v241
    v_perm_b32 v18, v96, v96, v242
    v_perm_b32 v19, v96, v96, v243
    v_perm_b32 v20, v96, v96, v244
    v_perm_b32 v21, v96, v96, v245
    v_perm_b32 v22, v96, v96, v246
    v_perm_b32 v23, v96, v96, v247
    v_mfma_f32_16x16x32_bf16 v[12:15], v[16:19], v[208:211], 0
    v_perm_b32 v16, v97, v97, v240
    v_perm_b32 v17, v97, v97, v241
    v_perm_b32 v18, v97, v97, v242
    v_perm_b32 v19, v97, v97, v243
    v_mfma_f32_16x16x32_bf16 v[12:15], v[20:23], v[212:215], v[12:15]
    v_perm_b32 v20, v97, v97, v244
    v_perm_b32 v21, v97, v97, v245
    v_perm_b32 v22, v97, v97, v246
    v_perm_b32 v23, v97, v97, v247
    v_mfma_f32_16x16x32_bf16 v[12:15], v[16:19], v[216:219], v[12:15]
    v_perm_b32 v16, v98, v98, v240
    v_perm_b32 v17, v98, v98, v241
    v_perm_b32 v18, v98, v98, v242
    v_perm_b32 v19, v98, v98, v243
    v_mfma_f32_16x16x32_bf16 v[12:15], v[20:23], v[220:223], v[12:15]
    v_perm_b32 v20, v98, v98, v244
    v_perm_b32 v21, v98, v98, v245
    v_perm_b32 v22, v98, v98, v246
    v_perm_b32 v23, v98, v98, v247
    v_mfma_f32_16x16x32_bf16 v[12:15], v[16:19], v[224:227], v[12:15]
    v_perm_b32 v16, v99, v99, v240
    v_perm_b32 v17, v99, v99, v241
    v_perm_b32 v18, v99, v99, v242
    v_perm_b32 v19, v99, v99, v243
    v_mfma_f32_16x16x32_bf16 v[12:15], v[20:23], v[228:231], v[12:15]
    v_perm_b32 v20, v99, v99, v244
    v_perm_b32 v21, v99, v99, v245
    v_perm_b32 v22, v99, v99, v246
    v_perm_b32 v23, v99, v99, v247
    v_mfma_f32_16x16x32_bf16 v[12:15], v[16:19], v[232:235], v[12:15]
    s_nop 0
    v_mfma_f32_16x16x32_bf16 v[12:15], v[20:23], v[236:239], v[12:15]
    s_nop 7
    ds_write_b128 v250, v[12:15] offset:4608
    s_mov_b64 exec, 1
    ds_add_rtn_u32 v37, v2, v251 offset:24
    s_mov_b64 exec, -1
    ds_read_b128 v[72:75], v1 offset:4608
    ds_read_b128 v[76:79], v1 offset:5632
    ds_read_b128 v[80:83], v1 offset:6656
    ds_read_b128 v[84:87], v1 offset:7680
    s_waitcnt lgkmcnt(4)
    v_readfirstlane_b32 s39, v37
    s_cmp_lg_u32 s39, 3
    s_cbranch_scc1 L_end
    s_waitcnt lgkmcnt(2)
    v_add_f32 v72, v72, v76
    v_add_f32 v73, v73, v77
    v_add_f32 v74, v74, v78
    v_add_f32 v75, v75, v79
    s_waitcnt lgkmcnt(0)
    v_add_f32 v80, v80, v84
    v_add_f32 v81, v81, v85
    v_add_f32 v82, v82, v86
    v_add_f32 v83, v83, v87
    v_add_f32 v72, v72, v80
    v_add_f32 v73, v73, v81
    v_add_f32 v74, v74, v82
    v_add_f32 v75, v75, v83
    v_bfi_b32 v72, v204, v200, v72
    v_bfi_b32 v73, v204, v201, v73
    v_bfi_b32 v74, v204, v202, v74
    v_bfi_b32 v75, v204, v203, v75
    buffer_store_dwordx4 v[72:75], v249, s[48:51], s99 offen sc1
    s_endpgm
L_helper:
    s_and_b32 s4, s4, 7
    s_lshr_b32 s36, s4, 2
    s_mov_b32 s50, 4194304
    s_mov_b32 s51, 0x20000
    v_bfe_u32 v2, v0, 4, 2
    v_and_b32 v3, 15, v0
    s_cmp_eq_u32 s3, 0
    s_cbranch_scc1 L_hq
    s_load_dwordx8 s[16:23], s[0:1], 32
    s_load_dwordx8 s[24:31], s[0:1], 64
    s_load_dwordx2 s[32:33], s[0:1], 96
    s_cmp_eq_u32 s3, 2
    s_cbranch_scc1 L_hp
    s_and_b32 s56, s2, 7
    s_lshr_b32 s39, s2, 3
    s_and_b32 s39, s39, 8
    s_add_u32 s56, s56, s39
    s_cmp_ge_u32 s56, 14
    s_cbranch_scc1 L_end
    s_cmp_ge_u32 s2, 128
    s_cbranch_scc1 L_hm2
    s_mov_b32 s5, s4
    s_movk_i32 s6, 3456
    s_lshl_b32 s59, s56, 13
    s_lshl_b32 s39, s5, 4
    s_add_u32 s59, s59, s39
    s_add_u32 s59, s59, 65536
    s_lshl_b32 s56, s56, 8
    s_mul_i32 s57, s5, 276480
    s_add_u32 s56, s56, s57
    s_sub_u32 s42, 2211840, s56
    s_waitcnt lgkmcnt(0)
    s_add_u32 s40, s20, s56
    s_addc_u32 s41, s21, 0
    s_branch L_g1
L_hq:
    s_mov_b32 s5, s4
    s_movk_i32 s6, 8192
    s_lshl_b32 s59, s34, 13
    s_lshl_b32 s39, s5, 10
    s_add_u32 s59, s59, s39
    s_add_u32 s59, s59, 262144
    s_lshl_b32 s56, s34, 8
    s_mul_i32 s57, s5, 655360
    s_add_u32 s56, s56, s57
    s_sub_u32 s42, 5242880, s56
    s_waitcnt lgkmcnt(0)
    s_add_u32 s40, s14, s56
    s_addc_u32 s41, s15, 0
    s_load_dwordx8 s[16:23], s[0:1], 32
    s_load_dwordx8 s[24:31], s[0:1], 64
    s_load_dwordx2 s[32:33], s[0:1], 96
L_g1:
    s_mov_b32 s44, s8
    s_mov_b32 s45, s9
    s_mov_b32 s46, 2560
    s_mov_b32 s47, 0x20000
    v_bfe_u32 v12, v1, 3, 1
    v_mul_u32_u24 v12, 1280, v12
    v_and_b32 v13, 7, v1
    v_lshl_add_u32 v13, v2, 3, v13
    v_lshl_add_u32 v13, v13, 3, v12
    buffer_load_dwordx2 v[50:51], v13, s[44:47], 0 offen offset:0
    buffer_load_dwordx2 v[52:53], v13, s[44:47], 0 offen offset:256
    buffer_load_dwordx2 v[54:55], v13, s[44:47], 0 offen offset:512
    buffer_load_dwordx2 v[56:57], v13, s[44:47], 0 offen offset:768
    buffer_load_dwordx2 v[58:59], v13, s[44:47], 0 offen offset:1024
    v_mul_u32_u24 v14, 40, v2
    v_add_u32 v14, v14, v12
    s_mul_i32 s39, s5, 160
    buffer_load_dwordx2 v[40:41], v14, s[44:47], s39 offen offset:0
    buffer_load_dwordx2 v[42:43], v14, s[44:47], s39 offen offset:8
    buffer_load_dwordx2 v[44:45], v14, s[44:47], s39 offen offset:16
    buffer_load_dwordx2 v[46:47], v14, s[44:47], s39 offen offset:24
    buffer_load_dwordx2 v[48:49], v14, s[44:47], s39 offen offset:32
    s_mul_i32 s39, s6, 20
    v_mul_lo_u32 v12, v2, s39
    v_lshl_add_u32 v92, v3, 4, v12
    s_mov_b32 s57, 0
    s_cmp_eq_u32 s3, 0
    s_cbranch_scc1 L_nb0
    s_barrier
L_nb0:
    s_cmp_eq_u32 s3, 0
    s_cbranch_scc1 L_nt0
    s_waitcnt vmcnt(0)
L_nt0:
    buffer_load_dwordx4 v[96:99], v92, s[40:43], s57 offen nt
    s_add_u32 s57, s57, s6
    buffer_load_dwordx4 v[100:103], v92, s[40:43], s57 offen nt
    s_add_u32 s57, s57, s6
    buffer_load_dwordx4 v[104:107], v92, s[40:43], s57 offen nt
    s_add_u32 s57, s57, s6
    buffer_load_dwordx4 v[108:111], v92, s[40:43], s57 offen nt
    s_add_u32 s57, s57, s6
    buffer_load_dwordx4 v[112:115], v92, s[40:43], s57 offen nt
    s_add_u32 s57, s57, s6
    buffer_load_dwordx4 v[116:119], v92, s[40:43], s57 offen nt
    s_add_u32 s57, s57, s6
    buffer_load_dwordx4 v[120:123], v92, s[40:43], s57 offen nt
    s_add_u32 s57, s57, s6
    buffer_load_dwordx4 v[124:127], v92, s[40:43], s57 offen nt
    s_add_u32 s57, s57, s6
    buffer_load_dwordx4 v[128:131], v92, s[40:43], s57 offen nt
    s_add_u32 s57, s57, s6
    buffer_load_dwordx4 v[132:135], v92, s[40:43], s57 offen nt
    s_add_u32 s57, s57, s6
    s_cmp_eq_u32 s3, 0
    s_cbranch_scc1 L_nt10
    s_waitcnt vmcnt(1)
L_nt10:
    buffer_load_dwordx4 v[136:139], v92, s[40:43], s57 offen nt
    s_add_u32 s57, s57, s6
    buffer_load_dwordx4 v[140:143], v92, s[40:43], s57 offen nt
    s_add_u32 s57, s57, s6
    buffer_load_dwordx4 v[144:147], v92, s[40:43], s57 offen nt
    s_add_u32 s57, s57, s6
    buffer_load_dwordx4 v[148:151], v92, s[40:43], s57 offen nt
    s_add_u32 s57, s57, s6
    buffer_load_dwordx4 v[152:155], v92, s[40:43], s57 offen nt
    s_add_u32 s57, s57, s6
    buffer_load_dwordx4 v[156:159], v92, s[40:43], s57 offen nt
    s_add_u32 s57, s57, s6
    buffer_load_dwordx4 v[160:163], v92, s[40:43], s57 offen nt
    s_add_u32 s57, s57, s6
    buffer_load_dwordx4 v[164:167], v92, s[40:43], s57 offen nt
    s_add_u32 s57, s57, s6
    buffer_load_dwordx4 v[168:171], v92, s[40:43], s57 offen nt
    s_add_u32 s57, s57, s6
    buffer_load_dwordx4 v[172:175], v92, s[40:43], s57 offen nt
    s_cmp_lg_u32 s3, 0
    s_cbranch_scc1 L_nb1
    s_barrier
L_nb1:
    s_waitcnt lgkmcnt(0)
    s_load_dwordx2 s[74:75], s[32:33], 49152
    s_mov_b32 s48, s32
    s_mov_b32 s49, s33
    v_lshrrev_b32 v12, 1, v2
    v_lshlrev_b32 v12, 9, v12
    v_lshl_add_u32 v12, v3, 5, v12
    v_and_b32 v13, 1, v2
    v_lshl_add_u32 v93, v13, 4, v12
    s_cmp_eq_u32 s3, 0
    s_cbranch_scc1 L_vst
    v_and_b32 v12, 3, v3
    v_lshl_add_u32 v12, v12, 1, v13
    v_lshlrev_b32 v12, 10, v12
    v_lshrrev_b32 v13, 2, v3
    v_lshl_add_u32 v12, v13, 8, v12
    v_lshrrev_b32 v13, 1, v2
    v_lshl_add_u32 v93, v13, 7, v12
L_vst:
    v_and_b32 v12, 7, v3
    v_lshrrev_b32 v13, 1, v12
    v_and_b32 v12, 1, v12
    v_mov_b32 v14, 0x0c0c0c0c
    v_cmp_eq_u32 vcc, 1, v12
    v_mov_b32 v15, 0x0c0c0100
    v_mov_b32 v16, 0x01000c0c
    v_cndmask_b32 v15, v15, v16, vcc
    v_mov_b32 v17, 0x0c0c0302
    v_mov_b32 v16, 0x03020c0c
    v_cndmask_b32 v17, v17, v16, vcc
    v_cmp_eq_u32 vcc, 0, v13
    s_nop 1
    v_cndmask_b32 v4, v14, v15, vcc
    v_cndmask_b32 v8, v14, v17, vcc
    v_cmp_eq_u32 vcc, 1, v13
    s_nop 1
    v_cndmask_b32 v5, v14, v15, vcc
    v_cndmask_b32 v9, v14, v17, vcc
    v_cmp_eq_u32 vcc, 2, v13
    s_nop 1
    v_cndmask_b32 v6, v14, v15, vcc
    v_cndmask_b32 v10, v14, v17, vcc
    v_cmp_eq_u32 vcc, 3, v13
    s_nop 1
    v_cndmask_b32 v7, v14, v15, vcc
    v_cndmask_b32 v11, v14, v17, vcc
    v_mov_b32 v20, 0x3f803f80
    s_waitcnt vmcnt(25)
    s_lshl_b32 s60, s3, 1
    s_add_u32 s60, s60, s34
    v_and_b32 v28, 7, v1
    v_lshlrev_b32 v28, 4, v28
    s_lshl_b32 s39, s60, 7
    s_add_u32 s39, s39, 40960
    buffer_load_dwordx4 v[24:27], v28, s[48:51], s39 offen sc1
    v_dot2_f32_bf16 v12, v50, v20, 0
    v_dot2_f32_bf16 v13, v51, v20, 0
    v_dot2_f32_bf16 v12, v52, v20, v12
    v_dot2_f32_bf16 v13, v53, v20, v13
    v_dot2_f32_bf16 v12, v54, v20, v12
    v_dot2_f32_bf16 v13, v55, v20, v13
    v_dot2_f32_bf16 v12, v56, v20, v12
    v_dot2_f32_bf16 v13, v57, v20, v13
    v_dot2_f32_bf16 v12, v58, v20, v12
    v_dot2_f32_bf16 v13, v59, v20, v13
    v_lshlrev_b32 v60, 16, v50
    v_and_b32 v61, 0xffff0000, v50
    v_lshlrev_b32 v62, 16, v51
    v_and_b32 v63, 0xffff0000, v51
    v_lshlrev_b32 v64, 16, v52
    v_and_b32 v65, 0xffff0000, v52
    v_lshlrev_b32 v66, 16, v53
    v_and_b32 v67, 0xffff0000, v53
    v_lshlrev_b32 v68, 16, v54
    v_and_b32 v69, 0xffff0000, v54
    v_lshlrev_b32 v70, 16, v55
    v_and_b32 v71, 0xffff0000, v55
    v_lshlrev_b32 v72, 16, v56
    v_and_b32 v73, 0xffff0000, v56
    v_lshlrev_b32 v74, 16, v57
    v_and_b32 v75, 0xffff0000, v57
    v_lshlrev_b32 v76, 16, v58
    v_and_b32 v77, 0xffff0000, v58
    v_lshlrev_b32 v78, 16, v59
    v_and_b32 v79, 0xffff0000, v59
    v_add_f32 v12, v12, v13
    s_nop 1
    v_add_f32_dpp v13, v12, v12 quad_perm:[1,0,3,2] row_mask:0xf bank_mask:0xf
    s_nop 1
    v_add_f32_dpp v12, v13, v13 quad_perm:[2,3,0,1] row_mask:0xf bank_mask:0xf
    s_nop 1
    v_add_f32_dpp v12, v12, v12 row_half_mirror row_mask:0xf bank_mask:0xf
    v_mov_b32 v13, v12
    s_nop 1
    v_permlane16_swap_b32 v12, v13
    v_add_f32 v12, v12, v13
    v_mov_b32 v13, v12
    s_nop 1
    v_permlane32_swap_b32 v12, v13
    v_add_f32 v12, v12, v13
    s_mov_b32 s39, 0x3acccccd
    v_mul_f32 v12, s39, v12
    v_mov_b32 v14, 0
    v_mov_b32 v15, 0
    v_sub_f32 v22, v60, v12
    v_sub_f32 v23, v61, v12
    v_fmac_f32 v14, v22, v22
    v_fmac_f32 v15, v23, v23
    v_sub_f32 v22, v62, v12
    v_sub_f32 v23, v63, v12
    v_fmac_f32 v14, v22, v22
    v_fmac_f32 v15, v23, v23
    v_sub_f32 v22, v64, v12
    v_sub_f32 v23, v65, v12
    v_fmac_f32 v14, v22, v22
    v_fmac_f32 v15, v23, v23
    v_sub_f32 v22, v66, v12
    v_sub_f32 v23, v67, v12
    v_fmac_f32 v14, v22, v22
    v_fmac_f32 v15, v23, v23
    v_sub_f32 v22, v68, v12
    v_sub_f32 v23, v69, v12
    v_fmac_f32 v14, v22, v22
    v_fmac_f32 v15, v23, v23
    v_sub_f32 v22, v70, v12
    v_sub_f32 v23, v71, v12
    v_fmac_f32 v14, v22, v22
    v_fmac_f32 v15, v23, v23
    v_sub_f32 v22, v72, v12
    v_sub_f32 v23, v73, v12
    v_fmac_f32 v14, v22, v22
    v_fmac_f32 v15, v23, v23
    v_sub_f32 v22, v74, v12
    v_sub_f32 v23, v75, v12
    v_fmac_f32 v14, v22, v22
    v_fmac_f32 v15, v23, v23
    v_sub_f32 v22, v76, v12
    v_sub_f32 v23, v77, v12
    v_fmac_f32 v14, v22, v22
    v_fmac_f32 v15, v23, v23
    v_sub_f32 v22, v78, v12
    v_sub_f32 v23, v79, v12
    v_fmac_f32 v14, v22, v22
    v_fmac_f32 v15, v23, v23
    v_add_f32 v14, v14, v15
    s_nop 1
    v_add_f32_dpp v15, v14, v14 quad_perm:[1,0,3,2] row_mask:0xf bank_mask:0xf
    s_nop 1
    v_add_f32_dpp v14, v15, v15 quad_perm:[2,3,0,1] row_mask:0xf bank_mask:0xf
    s_nop 1
    v_add_f32_dpp v14, v14, v14 row_half_mirror row_mask:0xf bank_mask:0xf
    v_mov_b32 v15, v14
    s_nop 1
    v_permlane16_swap_b32 v14, v15
    v_add_f32 v14, v14, v15
    v_mov_b32 v15, v14
    s_nop 1
    v_permlane32_swap_b32 v14, v15
    v_add_f32 v14, v14, v15
    v_mul_f32 v14, s39, v14
    v_cvt_pk_bf16_f32 v12, v12, v12
    v_lshlrev_b32 v12, 16, v12
    v_cvt_pk_bf16_f32 v14, v14, v14
    v_lshlrev_b32 v14, 16, v14
    v_add_f32 v14, 0x3727c5ac, v14
    v_cvt_pk_bf16_f32 v14, v14, v14
    v_lshlrev_b32 v14, 16, v14
    v_sqrt_f32 v14, v14
    s_nop 0
    v_cvt_pk_bf16_f32 v14, v14, v14
    v_lshlrev_b32 v14, 16, v14
    v_rcp_f32 v14, v14
    s_waitcnt vmcnt(21)
    v_lshlrev_b32 v60, 16, v40
    v_and_b32 v61, 0xffff0000, v40
    v_sub_f32 v60, v60, v12
    v_sub_f32 v61, v61, v12
    v_cvt_pk_bf16_f32 v40, v60, v61
    v_lshlrev_b32 v62, 16, v41
    v_and_b32 v63, 0xffff0000, v41
    v_sub_f32 v62, v62, v12
    v_sub_f32 v63, v63, v12
    v_cvt_pk_bf16_f32 v41, v62, v63
    v_lshlrev_b32 v64, 16, v42
    v_and_b32 v65, 0xffff0000, v42
    v_sub_f32 v64, v64, v12
    v_sub_f32 v65, v65, v12
    v_cvt_pk_bf16_f32 v42, v64, v65
    v_lshlrev_b32 v66, 16, v43
    v_and_b32 v67, 0xffff0000, v43
    v_sub_f32 v66, v66, v12
    v_sub_f32 v67, v67, v12
    v_cvt_pk_bf16_f32 v43, v66, v67
    v_lshlrev_b32 v68, 16, v44
    v_and_b32 v69, 0xffff0000, v44
    v_sub_f32 v68, v68, v12
    v_sub_f32 v69, v69, v12
    v_cvt_pk_bf16_f32 v44, v68, v69
    v_lshlrev_b32 v70, 16, v45
    v_and_b32 v71, 0xffff0000, v45
    v_sub_f32 v70, v70, v12
    v_sub_f32 v71, v71, v12
    v_cvt_pk_bf16_f32 v45, v70, v71
    v_lshlrev_b32 v72, 16, v46
    v_and_b32 v73, 0xffff0000, v46
    v_sub_f32 v72, v72, v12
    v_sub_f32 v73, v73, v12
    v_cvt_pk_bf16_f32 v46, v72, v73
    v_lshlrev_b32 v74, 16, v47
    v_and_b32 v75, 0xffff0000, v47
    v_sub_f32 v74, v74, v12
    v_sub_f32 v75, v75, v12
    v_cvt_pk_bf16_f32 v47, v74, v75
    v_lshlrev_b32 v76, 16, v48
    v_and_b32 v77, 0xffff0000, v48
    v_sub_f32 v76, v76, v12
    v_sub_f32 v77, v77, v12
    v_cvt_pk_bf16_f32 v48, v76, v77
    v_lshlrev_b32 v78, 16, v49
    v_and_b32 v79, 0xffff0000, v49
    v_sub_f32 v78, v78, v12
    v_sub_f32 v79, v79, v12
    v_cvt_pk_bf16_f32 v49, v78, v79
    v_lshlrev_b32 v60, 16, v40
    v_and_b32 v61, 0xffff0000, v40
    v_mul_f32 v60, v14, v60
    v_mul_f32 v61, v14, v61
    v_cvt_pk_bf16_f32 v40, v60, v61
    v_lshlrev_b32 v62, 16, v41
    v_and_b32 v63, 0xffff0000, v41
    v_mul_f32 v62, v14, v62
    v_mul_f32 v63, v14, v63
    v_cvt_pk_bf16_f32 v41, v62, v63
    v_lshlrev_b32 v64, 16, v42
    v_and_b32 v65, 0xffff0000, v42
    v_mul_f32 v64, v14, v64
    v_mul_f32 v65, v14, v65
    v_cvt_pk_bf16_f32 v42, v64, v65
    v_lshlrev_b32 v66, 16, v43
    v_and_b32 v67, 0xffff0000, v43
    v_mul_f32 v66, v14, v66
    v_mul_f32 v67, v14, v67
    v_cvt_pk_bf16_f32 v43, v66, v67
    v_lshlrev_b32 v68, 16, v44
    v_and_b32 v69, 0xffff0000, v44
    v_mul_f32 v68, v14, v68
    v_mul_f32 v69, v14, v69
    v_cvt_pk_bf16_f32 v44, v68, v69
    v_lshlrev_b32 v70, 16, v45
    v_and_b32 v71, 0xffff0000, v45
    v_mul_f32 v70, v14, v70
    v_mul_f32 v71, v14, v71
    v_cvt_pk_bf16_f32 v45, v70, v71
    v_lshlrev_b32 v72, 16, v46
    v_and_b32 v73, 0xffff0000, v46
    v_mul_f32 v72, v14, v72
    v_mul_f32 v73, v14, v73
    v_cvt_pk_bf16_f32 v46, v72, v73
    v_lshlrev_b32 v74, 16, v47
    v_and_b32 v75, 0xffff0000, v47
    v_mul_f32 v74, v14, v74
    v_mul_f32 v75, v14, v75
    v_cvt_pk_bf16_f32 v47, v74, v75
    v_lshlrev_b32 v76, 16, v48
    v_and_b32 v77, 0xffff0000, v48
    v_mul_f32 v76, v14, v76
    v_mul_f32 v77, v14, v77
    v_cvt_pk_bf16_f32 v48, v76, v77
    v_lshlrev_b32 v78, 16, v49
    v_and_b32 v79, 0xffff0000, v49
    v_mul_f32 v78, v14, v78
    v_mul_f32 v79, v14, v79
    v_cvt_pk_bf16_f32 v49, v78, v79
    s_waitcnt lgkmcnt(0)
    s_add_u32 s74, s74, 0x7f4a7c15
    s_addc_u32 s75, s75, 0x9e3779b9
    s_and_b32 s70, s74, 0xfff
    s_bfe_u32 s71, s74, 0xc000c
    s_lshr_b64 s[72:73], s[74:75], 24
    s_bfe_u32 s73, s72, 0xc000c
    s_and_b32 s72, s72, 0xfff
    v_mov_b32 v200, s70
    v_mov_b32 v201, s71
    v_mov_b32 v202, s72
    v_mov_b32 v203, s73
    v_mov_b32 v204, 0xfff
    v_perm_b32 v32, v40, v40, v4
    v_perm_b32 v33, v40, v40, v5
    v_perm_b32 v34, v40, v40, v6
    v_perm_b32 v35, v40, v40, v7
    v_perm_b32 v36, v40, v40, v8
    v_perm_b32 v37, v40, v40, v9
    v_perm_b32 v38, v40, v40, v10
    v_perm_b32 v39, v40, v40, v11
    s_waitcnt vmcnt(17)
    v_mfma_f32_16x16x32_bf16 v[12:15], v[32:35], v[96:99], 0
    v_perm_b32 v32, v41, v41, v4
    v_perm_b32 v33, v41, v41, v5
    v_perm_b32 v34, v41, v41, v6
    v_perm_b32 v35, v41, v41, v7
    v_mfma_f32_16x16x32_bf16 v[12:15], v[36:39], v[100:103], v[12:15]
    v_perm_b32 v36, v41, v41, v8
    v_perm_b32 v37, v41, v41, v9
    v_perm_b32 v38, v41, v41, v10
    v_perm_b32 v39, v41, v41, v11
    v_mfma_f32_16x16x32_bf16 v[12:15], v[32:35], v[104:107], v[12:15]
    v_perm_b32 v32, v42, v42, v4
    v_perm_b32 v33, v42, v42, v5
    v_perm_b32 v34, v42, v42, v6
    v_perm_b32 v35, v42, v42, v7
    v_mfma_f32_16x16x32_bf16 v[12:15], v[36:39], v[108:111], v[12:15]
    v_perm_b32 v36, v42, v42, v8
    v_perm_b32 v37, v42, v42, v9
    v_perm_b32 v38, v42, v42, v10
    v_perm_b32 v39, v42, v42, v11
    s_waitcnt vmcnt(13)
    v_mfma_f32_16x16x32_bf16 v[12:15], v[32:35], v[112:115], v[12:15]
    v_perm_b32 v32, v43, v43, v4
    v_perm_b32 v33, v43, v43, v5
    v_perm_b32 v34, v43, v43, v6
    v_perm_b32 v35, v43, v43, v7
    v_mfma_f32_16x16x32_bf16 v[12:15], v[36:39], v[116:119], v[12:15]
    v_perm_b32 v36, v43, v43, v8
    v_perm_b32 v37, v43, v43, v9
    v_perm_b32 v38, v43, v43, v10
    v_perm_b32 v39, v43, v43, v11
    v_mfma_f32_16x16x32_bf16 v[12:15], v[32:35], v[120:123], v[12:15]
    v_perm_b32 v32, v44, v44, v4
    v_perm_b32 v33, v44, v44, v5
    v_perm_b32 v34, v44, v44, v6
    v_perm_b32 v35, v44, v44, v7
    v_mfma_f32_16x16x32_bf16 v[12:15], v[36:39], v[124:127], v[12:15]
    v_perm_b32 v36, v44, v44, v8
    v_perm_b32 v37, v44, v44, v9
    v_perm_b32 v38, v44, v44, v10
    v_perm_b32 v39, v44, v44, v11
    s_waitcnt vmcnt(9)
    v_mfma_f32_16x16x32_bf16 v[12:15], v[32:35], v[128:131], v[12:15]
    v_perm_b32 v32, v45, v45, v4
    v_perm_b32 v33, v45, v45, v5
    v_perm_b32 v34, v45, v45, v6
    v_perm_b32 v35, v45, v45, v7
    v_mfma_f32_16x16x32_bf16 v[12:15], v[36:39], v[132:135], v[12:15]
    v_perm_b32 v36, v45, v45, v8
    v_perm_b32 v37, v45, v45, v9
    v_perm_b32 v38, v45, v45, v10
    v_perm_b32 v39, v45, v45, v11
    v_mfma_f32_16x16x32_bf16 v[12:15], v[32:35], v[136:139], v[12:15]
    v_perm_b32 v32, v46, v46, v4
    v_perm_b32 v33, v46, v46, v5
    v_perm_b32 v34, v46, v46, v6
    v_perm_b32 v35, v46, v46, v7
    v_mfma_f32_16x16x32_bf16 v[12:15], v[36:39], v[140:143], v[12:15]
    v_perm_b32 v36, v46, v46, v8
    v_perm_b32 v37, v46, v46, v9
    v_perm_b32 v38, v46, v46, v10
    v_perm_b32 v39, v46, v46, v11
    s_waitcnt vmcnt(5)
    v_mfma_f32_16x16x32_bf16 v[12:15], v[32:35], v[144:147], v[12:15]
    v_perm_b32 v32, v47, v47, v4
    v_perm_b32 v33, v47, v47, v5
    v_perm_b32 v34, v47, v47, v6
    v_perm_b32 v35, v47, v47, v7
    v_mfma_f32_16x16x32_bf16 v[12:15], v[36:39], v[148:151], v[12:15]
    v_perm_b32 v36, v47, v47, v8
    v_perm_b32 v37, v47, v47, v9
    v_perm_b32 v38, v47, v47, v10
    v_perm_b32 v39, v47, v47, v11
    v_mfma_f32_16x16x32_bf16 v[12:15], v[32:35], v[152:155], v[12:15]
    v_perm_b32 v32, v48, v48, v4
    v_perm_b32 v33, v48, v48, v5
    v_perm_b32 v34, v48, v48, v6
    v_perm_b32 v35, v48, v48, v7
    v_mfma_f32_16x16x32_bf16 v[12:15], v[36:39], v[156:159], v[12:15]
    v_perm_b32 v36, v48, v48, v8
    v_perm_b32 v37, v48, v48, v9
    v_perm_b32 v38, v48, v48, v10
    v_perm_b32 v39, v48, v48, v11
    s_waitcnt vmcnt(1)
    v_mfma_f32_16x16x32_bf16 v[12:15], v[32:35], v[160:163], v[12:15]
    v_perm_b32 v32, v49, v49, v4
    v_perm_b32 v33, v49, v49, v5
    v_perm_b32 v34, v49, v49, v6
    v_perm_b32 v35, v49, v49, v7
    v_mfma_f32_16x16x32_bf16 v[12:15], v[36:39], v[164:167], v[12:15]
    v_perm_b32 v36, v49, v49, v8
    v_perm_b32 v37, v49, v49, v9
    v_perm_b32 v38, v49, v49, v10
    v_perm_b32 v39, v49, v49, v11
    v_mfma_f32_16x16x32_bf16 v[12:15], v[32:35], v[168:171], v[12:15]
    s_nop 0
    v_mfma_f32_16x16x32_bf16 v[12:15], v[36:39], v[172:175], v[12:15]
    s_nop 7
    v_add_u32 v16, 0x800, v12
    v_bfi_b32 v16, v204, v200, v16
    v_add_u32 v17, 0x800, v13
    v_bfi_b32 v17, v204, v201, v17
    v_add_u32 v18, 0x800, v14
    v_bfi_b32 v18, v204, v202, v18
    v_add_u32 v19, 0x800, v15
    v_bfi_b32 v19, v204, v203, v19
    s_waitcnt vmcnt(0)
    s_getreg_b32 s39, hwreg(HW_REG_XCC_ID, 0, 4)
    v_xor_b32 v24, s39, v24
    v_xor_b32 v25, s74, v25
    v_xor_b32 v27, s75, v27
    v_or3_b32 v24, v24, v25, v27
    v_cmp_ne_u32 vcc, 0, v24
    s_nop 1
    s_cmp_eq_u64 vcc, 0
    s_cselect_b32 s62, 1, 0
    s_cbranch_scc0 L_g1s
    buffer_store_dwordx4 v[16:19], v93, s[48:51], s59 offen
    s_branch L_g1t
L_g1s:
    buffer_store_dwordx4 v[16:19], v93, s[48:51], s59 offen sc1
L_g1t:
    s_cmp_eq_u32 s3, 0
    s_cbranch_scc1 L_hq2
    s_endpgm
L_hq2:
    v_and_b32 v24, 31, v1
    v_lshlrev_b32 v24, 4, v24
    v_lshrrev_b32 v25, 5, v1
    v_lshl_add_u32 v24, v25, 10, v24
    s_lshl_b32 s56, s34, 13
    s_lshl_b32 s39, s36, 9
    s_add_u32 s56, s56, s39
    s_add_u32 s56, s56, 262144
    s_add_u32 s57, s56, 4096
    s_waitcnt vmcnt(0)
L_qb:
    s_mov_b32 s67, 131072
    s_movk_i32 s62, 0xf
L_qw:
    s_bitcmp1_b32 s62, 0
    s_cbranch_scc0 L_qs0
    buffer_load_dwordx4 v[76:79], v24, s[48:51], s56 offen offset:0 sc1
L_qs0:
    s_bitcmp1_b32 s62, 1
    s_cbranch_scc0 L_qs1
    buffer_load_dwordx4 v[80:83], v24, s[48:51], s56 offen offset:2048 sc1
L_qs1:
    s_bitcmp1_b32 s62, 2
    s_cbranch_scc0 L_qs2
    buffer_load_dwordx4 v[84:87], v24, s[48:51], s57 offen offset:0 sc1
L_qs2:
    s_bitcmp1_b32 s62, 3
    s_cbranch_scc0 L_qs3
    buffer_load_dwordx4 v[88:91], v24, s[48:51], s57 offen offset:2048 sc1
L_qs3:
    s_waitcnt vmcnt(0)
    s_mov_b32 s62, 0
    v_xor_b32 v60, v200, v76
    v_xor_b32 v61, v201, v77
    v_xor_b32 v62, v202, v78
    v_xor_b32 v63, v203, v79
    v_or3_b32 v25, v60, v61, v62
    v_or_b32 v25, v25, v63
    v_and_b32 v25, v204, v25
    v_cmp_ne_u32 vcc, 0, v25
    s_nop 0
    s_cmp_lg_u64 vcc, 0
    s_cselect_b32 s39, 1, 0
    s_or_b32 s62, s62, s39
    v_xor_b32 v64, v200, v80
    v_xor_b32 v65, v201, v81
    v_xor_b32 v66, v202, v82
    v_xor_b32 v67, v203, v83
    v_or3_b32 v25, v64, v65, v66
    v_or_b32 v25, v25, v67
    v_and_b32 v25, v204, v25
    v_cmp_ne_u32 vcc, 0, v25
    s_nop 0
    s_cmp_lg_u64 vcc, 0
    s_cselect_b32 s39, 2, 0
    s_or_b32 s62, s62, s39
    v_xor_b32 v68, v200, v84
    v_xor_b32 v69, v201, v85
    v_xor_b32 v70, v202, v86
    v_xor_b32 v71, v203, v87
    v_or3_b32 v25, v68, v69, v70
    v_or_b32 v25, v25, v71
    v_and_b32 v25, v204, v25
    v_cmp_ne_u32 vcc, 0, v25
    s_nop 0
    s_cmp_lg_u64 vcc, 0
    s_cselect_b32 s39, 4, 0
    s_or_b32 s62, s62, s39
    v_xor_b32 v72, v200, v88
    v_xor_b32 v73, v201, v89
    v_xor_b32 v74, v202, v90
    v_xor_b32 v75, v203, v91
    v_or3_b32 v25, v72, v73, v74
    v_or_b32 v25, v25, v75
    v_and_b32 v25, v204, v25
    v_cmp_ne_u32 vcc, 0, v25
    s_nop 0
    s_cmp_lg_u64 vcc, 0
    s_cselect_b32 s39, 8, 0
    s_or_b32 s62, s62, s39
    s_cbranch_scc0 L_qd
    s_sub_u32 s67, s67, 1
    s_cmp_lg_u32 s67, 0
    s_cbranch_scc1 L_qw
L_qd:
    v_add_f32 v60, v60, v64
    v_add_f32 v68, v68, v72
    v_add_f32 v61, v61, v65
    v_add_f32 v69, v69, v73
    v_add_f32 v62, v62, v66
    v_add_f32 v70, v70, v74
    v_add_f32 v63, v63, v67
    v_add_f32 v71, v71, v75
    v_add_f32 v60, v60, v68
    v_add_f32 v61, v61, v69
    v_add_f32 v62, v62, v70
    v_add_f32 v63, v63, v71
    s_nop 0
    v_permlane32_swap_b32 v60, v62
    v_permlane32_swap_b32 v61, v63
    v_add_f32 v60, v60, v62
    v_add_f32 v61, v61, v63
    v_cvt_pk_bf16_f32 v60, v60, v61
    v_and_b32 v22, 31, v1
    v_lshlrev_b32 v22, 3, v22
    v_lshrrev_b32 v23, 5, v1
    v_lshl_add_u32 v22, v23, 2, v22
    ds_write_b32 v22, v60 offset:0
    v_mov_b32 v28, 1
    v_mov_b32 v26, 272
    s_waitcnt lgkmcnt(0)
    ds_write_b32 v26, v28
    s_sub_u32 s61, s2, 176
    s_cmp_lt_u32 s61, 80
    s_cbranch_scc1 L_gate
    s_endpgm
L_gate:
    v_lshrrev_b32 v26, 2, v1
    v_min_u32 v19, 13, v26
    v_mul_u32_u24 v26, 5120, v26
    v_mul_u32_u24 v19, 5120, v19
    v_and_b32 v27, 3, v1
    v_lshl_add_u32 v26, v27, 4, v26
    v_lshl_add_u32 v19, v27, 4, v19
    v_lshlrev_b32 v27, 3, v27
    v_bfe_u32 v18, v1, 2, 2
    v_lshl_add_u32 v27, v18, 1, v27
    s_lshl_b32 s60, s61, 5
    buffer_load_ushort v20, v27, s[44:47], s60 offen
    s_cmp_ge_u32 s61, 40
    s_cselect_b32 s58, 40, 0
    s_sub_u32 s59, s61, s58
    s_lshl_b32 s57, s59, 5
    s_mov_b32 s52, s26
    s_mov_b32 s53, s27
    s_mov_b32 s54, 1280
    s_mov_b32 s55, 0x20000
    buffer_load_ushort v21, v27, s[52:55], s57 offen
    s_mul_i32 s56, s59, 52
    s_lshr_b32 s56, s56, 8
    s_mul_i32 s56, s56, 320
    s_lshl_b32 s57, s59, 6
    s_add_u32 s56, s56, s57
    s_lshl_b32 s58, s58, 3
    s_add_u32 s56, s56, s58
    s_add_u32 s8, s56, 1048576
    s_add_u32 s56, s56, 2097152
    s_add_u32 s57, s56, 81920
    s_mov_b32 s40, s28
    s_mov_b32 s41, s29
    s_movk_i32 s42, 2560
    v_mov_b32 v28, s74
    v_mov_b32 v29, s75
    v_lshlrev_b32 v30, 24, v1
    s_lshl_b32 s58, s61, 24
    s_add_u32 s58, s58, 49152
    s_mov_b32 s67, 1048576
    v_mov_b32 v16, 256
L_pw37:
    ds_read_b32 v17, v16
    s_waitcnt lgkmcnt(0)
    v_readfirstlane_b32 s39, v17
    s_cmp_ge_u32 s39, 4
    s_cbranch_scc1 L_pd37
    s_sleep 8
    s_sub_u32 s67, s67, 1
    s_cmp_lg_u32 s67, 0
    s_cbranch_scc1 L_pw37
L_pd37:
    s_mov_b32 s67, 131072
L_gw38:
    buffer_load_dwordx4 v[60:63], v19, s[48:51], s8 offen sc1
    s_waitcnt vmcnt(0)
    v_xor_b32 v60, s70, v60
    v_xor_b32 v61, s71, v61
    v_xor_b32 v62, s72, v62
    v_xor_b32 v63, s73, v63
    v_or3_b32 v18, v60, v61, v62
    v_or_b32 v18, v18, v63
    v_and_b32 v18, 0xfff, v18
    v_cmp_ne_u32 vcc, 0, v18
    s_nop 1
    s_cmp_eq_u64 vcc, 0
    s_cbranch_scc1 L_gd38
    s_sleep 32
    s_sub_u32 s67, s67, 1
    s_cmp_lg_u32 s67, 0
    s_cbranch_scc1 L_gw38
L_gd38:
    v_cmp_gt_u32 vcc, 56, v1
    s_nop 1
    v_cndmask_b32 v60, 0, v60, vcc
    v_cndmask_b32 v61, 0, v61, vcc
    v_cndmask_b32 v62, 0, v62, vcc
    v_cndmask_b32 v63, 0, v63, vcc
    v_add_f32_dpp v64, v60, v60 row_ror:4 row_mask:0xf bank_mask:0xf
    v_add_f32_dpp v65, v61, v61 row_ror:4 row_mask:0xf bank_mask:0xf
    v_add_f32_dpp v66, v62, v62 row_ror:4 row_mask:0xf bank_mask:0xf
    v_add_f32_dpp v67, v63, v63 row_ror:4 row_mask:0xf bank_mask:0xf
    v_add_f32_dpp v18, v64, v64 row_ror:8 row_mask:0xf bank_mask:0x1
    v_add_f32_dpp v18, v65, v65 row_ror:8 row_mask:0xf bank_mask:0x2
    v_add_f32_dpp v18, v66, v66 row_ror:8 row_mask:0xf bank_mask:0x4
    v_add_f32_dpp v18, v67, v67 row_ror:8 row_mask:0xf bank_mask:0x8
    v_mov_b32 v19, v18
    s_nop 1
    v_permlane16_swap_b32 v18, v19
    v_add_f32 v18, v18, v19
    v_mov_b32 v19, v18
    s_nop 1
    v_permlane32_swap_b32 v18, v19
    v_add_f32 v18, v18, v19
    v_cvt_pk_bf16_f32 v18, v18, v18
    v_lshlrev_b32 v18, 16, v18
    v_lshlrev_b32 v21, 16, v21
    v_lshlrev_b32 v20, 16, v20
    v_add_f32 v18, v18, v21
    v_cvt_pk_bf16_f32 v18, v18, v18
    v_lshlrev_b32 v18, 16, v18
    v_mul_f32 v19, 0xbfb8aa3b, v18
    v_exp_f32 v19, v19
    s_nop 0
    v_add_f32 v19, 1.0, v19
    v_rcp_f32 v19, v19
    s_nop 0
    v_mul_f32 v18, v18, v19
    v_cvt_pk_bf16_f32 v22, v18, v18
    v_lshlrev_b32 v22, 16, v22
    s_mov_b32 s67, 1048576
    v_mov_b32 v16, 256
L_pw39:
    ds_read_b32 v17, v16
    s_waitcnt lgkmcnt(0)
    v_readfirstlane_b32 s39, v17
    s_cmp_ge_u32 s39, 8
    s_cbranch_scc1 L_pd39
    s_sleep 8
    s_sub_u32 s67, s67, 1
    s_cmp_lg_u32 s67, 0
    s_cbranch_scc1 L_pw39
L_pd39:
    s_mov_b32 s67, 1048576
    v_mov_b32 v16, 280
L_pw40:
    ds_read_b32 v17, v16
    s_waitcnt lgkmcnt(0)
    v_readfirstlane_b32 s39, v17
    s_cmp_ge_u32 s39, 4
    s_cbranch_scc1 L_pd40
    s_sub_u32 s67, s67, 1
    s_cmp_lg_u32 s67, 0
    s_cbranch_scc1 L_pw40
L_pd40:
    s_sleep 18
    s_mov_b32 s67, 131072
L_gw41:
    buffer_load_dwordx4 v[60:63], v26, s[48:51], s56 offen sc1
    buffer_load_dwordx4 v[64:67], v26, s[48:51], s57 offen sc1
    s_waitcnt vmcnt(0)
    v_xor_b32 v60, s70, v60
    v_xor_b32 v61, s71, v61
    v_xor_b32 v62, s72, v62
    v_xor_b32 v63, s73, v63
    v_or3_b32 v18, v60, v61, v62
    v_or_b32 v18, v18, v63
    v_xor_b32 v64, s70, v64
    v_xor_b32 v65, s71, v65
    v_xor_b32 v66, s72, v66
    v_xor_b32 v67, s73, v67
    v_or3_b32 v18, v18, v64, v65
    v_or3_b32 v18, v18, v66, v67
    v_and_b32 v18, 0xfff, v18
    v_cmp_ne_u32 vcc, 0, v18
    s_nop 1
    s_cmp_eq_u64 vcc, 0
    s_cbranch_scc1 L_gd41
    s_sub_u32 s67, s67, 1
    s_cmp_lg_u32 s67, 0
    s_cbranch_scc1 L_gw41
L_gd41:
    v_add_f32 v60, v60, v64
    v_add_f32 v61, v61, v65
    v_add_f32 v62, v62, v66
    v_add_f32 v63, v63, v67
    v_add_f32_dpp v64, v60, v60 row_ror:4 row_mask:0xf bank_mask:0xf
    v_add_f32_dpp v65, v61, v61 row_ror:4 row_mask:0xf bank_mask:0xf
    v_add_f32_dpp v66, v62, v62 row_ror:4 row_mask:0xf bank_mask:0xf
    v_add_f32_dpp v67, v63, v63 row_ror:4 row_mask:0xf bank_mask:0xf
    v_add_f32_dpp v18, v64, v64 row_ror:8 row_mask:0xf bank_mask:0x1
    v_add_f32_dpp v18, v65, v65 row_ror:8 row_mask:0xf bank_mask:0x2
    v_add_f32_dpp v18, v66, v66 row_ror:8 row_mask:0xf bank_mask:0x4
    v_add_f32_dpp v18, v67, v67 row_ror:8 row_mask:0xf bank_mask:0x8
    v_mov_b32 v19, v18
    s_nop 1
    v_permlane16_swap_b32 v18, v19
    v_add_f32 v18, v18, v19
    v_mov_b32 v19, v18
    s_nop 1
    v_permlane32_swap_b32 v18, v19
    v_add_f32 v18, v18, v19
    v_cvt_pk_bf16_f32 v18, v18, v18
    v_lshlrev_b32 v18, 16, v18
    v_mul_f32 v18, v18, v22
    v_cvt_pk_bf16_f32 v18, v18, v18
    v_lshlrev_b32 v18, 16, v18
    v_add_f32 v18, v18, v20
    v_cvt_pk_bf16_f32 v18, v18, v18
    buffer_store_short v18, v27, s[40:43], s60 offen
    buffer_store_dwordx2 v[28:29], v30, s[48:51], s58 offen
    s_endpgm
L_hm2:
    s_mov_b32 s5, s56
    s_mov_b32 s6, s4
    s_lshl_b32 s59, s5, 3
    s_add_u32 s59, s59, s6
    s_mul_i32 s59, s59, 640
    s_add_u32 s59, s59, 1048576
    s_mul_i32 s56, s5, 163840
    s_mul_i32 s57, s6, 160
    s_add_u32 s56, s56, s57
    s_sub_u32 s42, 2211840, s56
    s_waitcnt lgkmcnt(0)
    s_add_u32 s40, s24, s56
    s_addc_u32 s41, s25, 0
    s_load_dwordx2 s[74:75], s[32:33], 49152
    s_barrier
    s_mov_b32 s48, s32
    s_mov_b32 s49, s33
    v_mul_u32_u24 v16, 40960, v2
    v_lshl_add_u32 v16, v3, 4, v16
    v_mov_b32 v18, 0x40000000
    v_cmp_gt_u32 vcc, 10, v3
    s_nop 1
    v_cndmask_b32 v92, v18, v16, vcc
    v_lshrrev_b32 v16, 1, v2
    v_mul_u32_u24 v16, 320, v16
    v_lshl_add_u32 v16, v3, 5, v16
    v_and_b32 v17, 1, v2
    v_lshl_add_u32 v16, v17, 4, v16
    v_cndmask_b32 v93, v18, v16, vcc
    v_and_b32 v12, 7, v3
    v_lshrrev_b32 v13, 1, v12
    v_and_b32 v12, 1, v12
    v_mov_b32 v14, 0x0c0c0c0c
    v_cmp_eq_u32 vcc, 1, v12
    v_mov_b32 v15, 0x0c0c0100
    v_mov_b32 v16, 0x01000c0c
    v_cndmask_b32 v15, v15, v16, vcc
    v_mov_b32 v17, 0x0c0c0302
    v_mov_b32 v16, 0x03020c0c
    v_cndmask_b32 v17, v17, v16, vcc
    v_cmp_eq_u32 vcc, 0, v13
    s_nop 1
    v_cndmask_b32 v4, v14, v15, vcc
    v_cndmask_b32 v8, v14, v17, vcc
    v_cmp_eq_u32 vcc, 1, v13
    s_nop 1
    v_cndmask_b32 v5, v14, v15, vcc
    v_cndmask_b32 v9, v14, v17, vcc
    v_cmp_eq_u32 vcc, 2, v13
    s_nop 1
    v_cndmask_b32 v6, v14, v15, vcc
    v_cndmask_b32 v10, v14, v17, vcc
    v_cmp_eq_u32 vcc, 3, v13
    s_nop 1
    v_cndmask_b32 v7, v14, v15, vcc
    v_cndmask_b32 v11, v14, v17, vcc
    v_and_b32 v94, 7, v3
    v_lshlrev_b32 v94, 10, v94
    v_lshrrev_b32 v95, 3, v3
    v_lshl_add_u32 v94, v95, 9, v94
    v_lshl_add_u32 v94, v2, 7, v94
    s_mov_b32 s52, s22
    s_mov_b32 s53, s23
    s_mov_b32 s54, 3456
    s_mov_b32 s55, 0x20000
    s_waitcnt lgkmcnt(0)
    s_add_u32 s74, s74, 0x7f4a7c15
    s_addc_u32 s75, s75, 0x9e3779b9
    s_and_b32 s70, s74, 0xfff
    s_bfe_u32 s71, s74, 0xc000c
    s_lshr_b64 s[72:73], s[74:75], 24
    s_bfe_u32 s73, s72, 0xc000c
    s_and_b32 s72, s72, 0xfff
    v_mov_b32 v240, s70
    v_mov_b32 v241, s71
    v_mov_b32 v242, s72
    v_mov_b32 v243, s73
    v_mov_b32 v244, 0xfff
    s_mov_b32 s57, 0
    buffer_load_dwordx4 v[96:99], v92, s[40:43], s57 offen nt
    s_addk_i32 s57, 1280
    buffer_load_dwordx4 v[100:103], v92, s[40:43], s57 offen nt
    s_addk_i32 s57, 1280
    buffer_load_dwordx4 v[104:107], v92, s[40:43], s57 offen nt
    s_addk_i32 s57, 1280
    buffer_load_dwordx4 v[108:111], v92, s[40:43], s57 offen nt
    s_addk_i32 s57, 1280
    buffer_load_dwordx4 v[112:115], v92, s[40:43], s57 offen nt
    s_addk_i32 s57, 1280
    buffer_load_dwordx4 v[116:119], v92, s[40:43], s57 offen nt
    s_addk_i32 s57, 1280
    buffer_load_dwordx4 v[120:123], v92, s[40:43], s57 offen nt
    s_addk_i32 s57, 1280
    buffer_load_dwordx4 v[124:127], v92, s[40:43], s57 offen nt
    s_addk_i32 s57, 1280
    s_waitcnt vmcnt(7)
    buffer_load_dwordx4 v[128:131], v92, s[40:43], s57 offen nt
    s_addk_i32 s57, 1280
    s_waitcnt vmcnt(7)
    buffer_load_dwordx4 v[132:135], v92, s[40:43], s57 offen nt
    s_addk_i32 s57, 1280
    s_waitcnt vmcnt(7)
    buffer_load_dwordx4 v[136:139], v92, s[40:43], s57 offen nt
    s_addk_i32 s57, 1280
    s_waitcnt vmcnt(7)
    buffer_load_dwordx4 v[140:143], v92, s[40:43], s57 offen nt
    s_addk_i32 s57, 1280
    s_waitcnt vmcnt(7)
    buffer_load_dwordx4 v[144:147], v92, s[40:43], s57 offen nt
    s_addk_i32 s57, 1280
    s_waitcnt vmcnt(7)
    buffer_load_dwordx4 v[148:151], v92, s[40:43], s57 offen nt
    s_addk_i32 s57, 1280
    s_waitcnt vmcnt(7)
    buffer_load_dwordx4 v[152:155], v92, s[40:43], s57 offen nt
    s_addk_i32 s57, 1280
    s_waitcnt vmcnt(7)
    buffer_load_dwordx4 v[156:159], v92, s[40:43], s57 offen nt
    s_addk_i32 s57, 1280
    s_waitcnt vmcnt(7)
    buffer_load_dwordx4 v[160:163], v92, s[40:43], s57 offen nt
    s_addk_i32 s57, 1280
    s_waitcnt vmcnt(7)
    buffer_load_dwordx4 v[164:167], v92, s[40:43], s57 offen nt
    s_addk_i32 s57, 1280
    s_waitcnt vmcnt(7)
    buffer_load_dwordx4 v[168:171], v92, s[40:43], s57 offen nt
    s_addk_i32 s57, 1280
    s_waitcnt vmcnt(7)
    buffer_load_dwordx4 v[172:175], v92, s[40:43], s57 offen nt
    s_addk_i32 s57, 1280
    s_waitcnt vmcnt(7)
    buffer_load_dwordx4 v[176:179], v92, s[40:43], s57 offen nt
    s_addk_i32 s57, 1280
    s_waitcnt vmcnt(7)
    buffer_load_dwordx4 v[180:183], v92, s[40:43], s57 offen nt
    s_addk_i32 s57, 1280
    s_waitcnt vmcnt(7)
    buffer_load_dwordx4 v[184:187], v92, s[40:43], s57 offen nt
    s_addk_i32 s57, 1280
    s_waitcnt vmcnt(7)
    buffer_load_dwordx4 v[188:191], v92, s[40:43], s57 offen nt
    s_addk_i32 s57, 1280
    s_waitcnt vmcnt(7)
    buffer_load_dwordx4 v[192:195], v92, s[40:43], s57 offen nt
    s_addk_i32 s57, 1280
    s_waitcnt vmcnt(7)
    buffer_load_dwordx4 v[196:199], v92, s[40:43], s57 offen nt
    s_addk_i32 s57, 1280
    s_waitcnt vmcnt(7)
    buffer_load_dwordx4 v[200:203], v92, s[40:43], s57 offen nt
    s_addk_i32 s57, 1280
    s_waitcnt vmcnt(7)
    buffer_load_dwordx4 v[204:207], v92, s[40:43], s57 offen nt
    s_addk_i32 s57, 1280
    s_waitcnt vmcnt(7)
    buffer_load_dwordx4 v[208:211], v92, s[40:43], s57 offen nt
    s_addk_i32 s57, 1280
    s_waitcnt vmcnt(7)
    buffer_load_dwordx4 v[212:215], v92, s[40:43], s57 offen nt
    s_addk_i32 s57, 1280
    s_waitcnt vmcnt(7)
    buffer_load_dwordx4 v[216:219], v92, s[40:43], s57 offen nt
    s_addk_i32 s57, 1280
    s_waitcnt vmcnt(7)
    buffer_load_dwordx4 v[220:223], v92, s[40:43], s57 offen nt
    s_lshl_b32 s57, s5, 8
    v_lshlrev_b32 v20, 6, v2
    buffer_load_dwordx4 v[224:227], v20, s[52:55], s57 offen offset:0
    buffer_load_dwordx4 v[228:231], v20, s[52:55], s57 offen offset:16
    buffer_load_dwordx4 v[232:235], v20, s[52:55], s57 offen offset:32
    buffer_load_dwordx4 v[236:239], v20, s[52:55], s57 offen offset:48
    s_mov_b32 s67, 1048576
    v_mov_b32 v16, 256
L_pw42:
    ds_read_b32 v17, v16
    s_waitcnt lgkmcnt(0)
    v_readfirstlane_b32 s39, v17
    s_cmp_ge_u32 s39, 1
    s_cbranch_scc1 L_pd42
    s_sleep 8
    s_sub_u32 s67, s67, 1
    s_cmp_lg_u32 s67, 0
    s_cbranch_scc1 L_pw42
L_pd42:
    s_lshl_b32 s56, s5, 13
    s_add_u32 s56, s56, 65536
    v_lshlrev_b32 v94, 4, v1
    s_add_u32 s57, s56, 4096
    s_mov_b32 s67, 131072
L_gw43:
    buffer_load_dwordx4 v[60:63], v94, s[48:51], s56 offen offset:0 sc1
    buffer_load_dwordx4 v[64:67], v94, s[48:51], s56 offen offset:1024 sc1
    buffer_load_dwordx4 v[68:71], v94, s[48:51], s56 offen offset:2048 sc1
    buffer_load_dwordx4 v[72:75], v94, s[48:51], s56 offen offset:3072 sc1
    buffer_load_dwordx4 v[76:79], v94, s[48:51], s57 offen offset:0 sc1
    buffer_load_dwordx4 v[80:83], v94, s[48:51], s57 offen offset:1024 sc1
    buffer_load_dwordx4 v[84:87], v94, s[48:51], s57 offen offset:2048 sc1
    buffer_load_dwordx4 v[88:91], v94, s[48:51], s57 offen offset:3072 sc1
    s_waitcnt vmcnt(0)
    v_xor_b32 v60, s70, v60
    v_xor_b32 v61, s71, v61
    v_xor_b32 v62, s72, v62
    v_xor_b32 v63, s73, v63
    v_or3_b32 v18, v60, v61, v62
    v_or_b32 v18, v18, v63
    v_xor_b32 v64, s70, v64
    v_xor_b32 v65, s71, v65
    v_xor_b32 v66, s72, v66
    v_xor_b32 v67, s73, v67
    v_or3_b32 v18, v18, v64, v65
    v_or3_b32 v18, v18, v66, v67
    v_xor_b32 v68, s70, v68
    v_xor_b32 v69, s71, v69
    v_xor_b32 v70, s72, v70
    v_xor_b32 v71, s73, v71
    v_or3_b32 v18, v18, v68, v69
    v_or3_b32 v18, v18, v70, v71
    v_xor_b32 v72, s70, v72
    v_xor_b32 v73, s71, v73
    v_xor_b32 v74, s72, v74
    v_xor_b32 v75, s73, v75
    v_or3_b32 v18, v18, v72, v73
    v_or3_b32 v18, v18, v74, v75
    v_xor_b32 v76, s70, v76
    v_xor_b32 v77, s71, v77
    v_xor_b32 v78, s72, v78
    v_xor_b32 v79, s73, v79
    v_or3_b32 v18, v18, v76, v77
    v_or3_b32 v18, v18, v78, v79
    v_xor_b32 v80, s70, v80
    v_xor_b32 v81, s71, v81
    v_xor_b32 v82, s72, v82
    v_xor_b32 v83, s73, v83
    v_or3_b32 v18, v18, v80, v81
    v_or3_b32 v18, v18, v82, v83
    v_xor_b32 v84, s70, v84
    v_xor_b32 v85, s71, v85
    v_xor_b32 v86, s72, v86
    v_xor_b32 v87, s73, v87
    v_or3_b32 v18, v18, v84, v85
    v_or3_b32 v18, v18, v86, v87
    v_xor_b32 v88, s70, v88
    v_xor_b32 v89, s71, v89
    v_xor_b32 v90, s72, v90
    v_xor_b32 v91, s73, v91
    v_or3_b32 v18, v18, v88, v89
    v_or3_b32 v18, v18, v90, v91
    v_and_b32 v18, 0xfff, v18
    v_cmp_ne_u32 vcc, 0, v18
    s_nop 1
    s_cmp_eq_u64 vcc, 0
    s_cbranch_scc1 L_gd43
    s_sleep 32
    s_sub_u32 s67, s67, 1
    s_cmp_lg_u32 s67, 0
    s_cbranch_scc1 L_gw43
L_gd43:
    v_add_f32_dpp v20, v60, v60 quad_perm:[1,0,3,2] row_mask:0xf bank_mask:0xf
    v_add_f32_dpp v21, v61, v61 quad_perm:[1,0,3,2] row_mask:0xf bank_mask:0xf
    v_add_f32_dpp v22, v62, v62 quad_perm:[1,0,3,2] row_mask:0xf bank_mask:0xf
    v_add_f32_dpp v23, v63, v63 quad_perm:[1,0,3,2] row_mask:0xf bank_mask:0xf
    v_add_f32_dpp v60, v20, v20 quad_perm:[2,3,0,1] row_mask:0xf bank_mask:0xf
    v_add_f32_dpp v61, v21, v21 quad_perm:[2,3,0,1] row_mask:0xf bank_mask:0xf
    v_add_f32_dpp v62, v22, v22 quad_perm:[2,3,0,1] row_mask:0xf bank_mask:0xf
    v_add_f32_dpp v63, v23, v23 quad_perm:[2,3,0,1] row_mask:0xf bank_mask:0xf
    v_add_f32_dpp v60, v60, v60 row_half_mirror row_mask:0xf bank_mask:0xf
    v_add_f32_dpp v61, v61, v61 row_half_mirror row_mask:0xf bank_mask:0xf
    v_add_f32_dpp v62, v62, v62 row_half_mirror row_mask:0xf bank_mask:0xf
    v_add_f32_dpp v63, v63, v63 row_half_mirror row_mask:0xf bank_mask:0xf
    v_add_f32_dpp v20, v64, v64 quad_perm:[1,0,3,2] row_mask:0xf bank_mask:0xf
    v_add_f32_dpp v21, v65, v65 quad_perm:[1,0,3,2] row_mask:0xf bank_mask:0xf
    v_add_f32_dpp v22, v66, v66 quad_perm:[1,0,3,2] row_mask:0xf bank_mask:0xf
    v_add_f32_dpp v23, v67, v67 quad_perm:[1,0,3,2] row_mask:0xf bank_mask:0xf
    v_add_f32_dpp v64, v20, v20 quad_perm:[2,3,0,1] row_mask:0xf bank_mask:0xf
    v_add_f32_dpp v65, v21, v21 quad_perm:[2,3,0,1] row_mask:0xf bank_mask:0xf
    v_add_f32_dpp v66, v22, v22 quad_perm:[2,3,0,1] row_mask:0xf bank_mask:0xf
    v_add_f32_dpp v67, v23, v23 quad_perm:[2,3,0,1] row_mask:0xf bank_mask:0xf
    v_add_f32_dpp v64, v64, v64 row_half_mirror row_mask:0xf bank_mask:0xf
    v_add_f32_dpp v65, v65, v65 row_half_mirror row_mask:0xf bank_mask:0xf
    v_add_f32_dpp v66, v66, v66 row_half_mirror row_mask:0xf bank_mask:0xf
    v_add_f32_dpp v67, v67, v67 row_half_mirror row_mask:0xf bank_mask:0xf
    v_add_f32_dpp v20, v68, v68 quad_perm:[1,0,3,2] row_mask:0xf bank_mask:0xf
    v_add_f32_dpp v21, v69, v69 quad_perm:[1,0,3,2] row_mask:0xf bank_mask:0xf
    v_add_f32_dpp v22, v70, v70 quad_perm:[1,0,3,2] row_mask:0xf bank_mask:0xf
    v_add_f32_dpp v23, v71, v71 quad_perm:[1,0,3,2] row_mask:0xf bank_mask:0xf
    v_add_f32_dpp v68, v20, v20 quad_perm:[2,3,0,1] row_mask:0xf bank_mask:0xf
    v_add_f32_dpp v69, v21, v21 quad_perm:[2,3,0,1] row_mask:0xf bank_mask:0xf
    v_add_f32_dpp v70, v22, v22 quad_perm:[2,3,0,1] row_mask:0xf bank_mask:0xf
    v_add_f32_dpp v71, v23, v23 quad_perm:[2,3,0,1] row_mask:0xf bank_mask:0xf
    v_add_f32_dpp v68, v68, v68 row_half_mirror row_mask:0xf bank_mask:0xf
    v_add_f32_dpp v69, v69, v69 row_half_mirror row_mask:0xf bank_mask:0xf
    v_add_f32_dpp v70, v70, v70 row_half_mirror row_mask:0xf bank_mask:0xf
    v_add_f32_dpp v71, v71, v71 row_half_mirror row_mask:0xf bank_mask:0xf
    v_add_f32_dpp v20, v72, v72 quad_perm:[1,0,3,2] row_mask:0xf bank_mask:0xf
    v_add_f32_dpp v21, v73, v73 quad_perm:[1,0,3,2] row_mask:0xf bank_mask:0xf
    v_add_f32_dpp v22, v74, v74 quad_perm:[1,0,3,2] row_mask:0xf bank_mask:0xf
    v_add_f32_dpp v23, v75, v75 quad_perm:[1,0,3,2] row_mask:0xf bank_mask:0xf
    v_add_f32_dpp v72, v20, v20 quad_perm:[2,3,0,1] row_mask:0xf bank_mask:0xf
    v_add_f32_dpp v73, v21, v21 quad_perm:[2,3,0,1] row_mask:0xf bank_mask:0xf
    v_add_f32_dpp v74, v22, v22 quad_perm:[2,3,0,1] row_mask:0xf bank_mask:0xf
    v_add_f32_dpp v75, v23, v23 quad_perm:[2,3,0,1] row_mask:0xf bank_mask:0xf
    v_add_f32_dpp v72, v72, v72 row_half_mirror row_mask:0xf bank_mask:0xf
    v_add_f32_dpp v73, v73, v73 row_half_mirror row_mask:0xf bank_mask:0xf
    v_add_f32_dpp v74, v74, v74 row_half_mirror row_mask:0xf bank_mask:0xf
    v_add_f32_dpp v75, v75, v75 row_half_mirror row_mask:0xf bank_mask:0xf
    v_add_f32_dpp v20, v76, v76 quad_perm:[1,0,3,2] row_mask:0xf bank_mask:0xf
    v_add_f32_dpp v21, v77, v77 quad_perm:[1,0,3,2] row_mask:0xf bank_mask:0xf
    v_add_f32_dpp v22, v78, v78 quad_perm:[1,0,3,2] row_mask:0xf bank_mask:0xf
    v_add_f32_dpp v23, v79, v79 quad_perm:[1,0,3,2] row_mask:0xf bank_mask:0xf
    v_add_f32_dpp v76, v20, v20 quad_perm:[2,3,0,1] row_mask:0xf bank_mask:0xf
    v_add_f32_dpp v77, v21, v21 quad_perm:[2,3,0,1] row_mask:0xf bank_mask:0xf
    v_add_f32_dpp v78, v22, v22 quad_perm:[2,3,0,1] row_mask:0xf bank_mask:0xf
    v_add_f32_dpp v79, v23, v23 quad_perm:[2,3,0,1] row_mask:0xf bank_mask:0xf
    v_add_f32_dpp v76, v76, v76 row_half_mirror row_mask:0xf bank_mask:0xf
    v_add_f32_dpp v77, v77, v77 row_half_mirror row_mask:0xf bank_mask:0xf
    v_add_f32_dpp v78, v78, v78 row_half_mirror row_mask:0xf bank_mask:0xf
    v_add_f32_dpp v79, v79, v79 row_half_mirror row_mask:0xf bank_mask:0xf
    v_add_f32_dpp v20, v80, v80 quad_perm:[1,0,3,2] row_mask:0xf bank_mask:0xf
    v_add_f32_dpp v21, v81, v81 quad_perm:[1,0,3,2] row_mask:0xf bank_mask:0xf
    v_add_f32_dpp v22, v82, v82 quad_perm:[1,0,3,2] row_mask:0xf bank_mask:0xf
    v_add_f32_dpp v23, v83, v83 quad_perm:[1,0,3,2] row_mask:0xf bank_mask:0xf
    v_add_f32_dpp v80, v20, v20 quad_perm:[2,3,0,1] row_mask:0xf bank_mask:0xf
    v_add_f32_dpp v81, v21, v21 quad_perm:[2,3,0,1] row_mask:0xf bank_mask:0xf
    v_add_f32_dpp v82, v22, v22 quad_perm:[2,3,0,1] row_mask:0xf bank_mask:0xf
    v_add_f32_dpp v83, v23, v23 quad_perm:[2,3,0,1] row_mask:0xf bank_mask:0xf
    v_add_f32_dpp v80, v80, v80 row_half_mirror row_mask:0xf bank_mask:0xf
    v_add_f32_dpp v81, v81, v81 row_half_mirror row_mask:0xf bank_mask:0xf
    v_add_f32_dpp v82, v82, v82 row_half_mirror row_mask:0xf bank_mask:0xf
    v_add_f32_dpp v83, v83, v83 row_half_mirror row_mask:0xf bank_mask:0xf
    v_add_f32_dpp v20, v84, v84 quad_perm:[1,0,3,2] row_mask:0xf bank_mask:0xf
    v_add_f32_dpp v21, v85, v85 quad_perm:[1,0,3,2] row_mask:0xf bank_mask:0xf
    v_add_f32_dpp v22, v86, v86 quad_perm:[1,0,3,2] row_mask:0xf bank_mask:0xf
    v_add_f32_dpp v23, v87, v87 quad_perm:[1,0,3,2] row_mask:0xf bank_mask:0xf
    v_add_f32_dpp v84, v20, v20 quad_perm:[2,3,0,1] row_mask:0xf bank_mask:0xf
    v_add_f32_dpp v85, v21, v21 quad_perm:[2,3,0,1] row_mask:0xf bank_mask:0xf
    v_add_f32_dpp v86, v22, v22 quad_perm:[2,3,0,1] row_mask:0xf bank_mask:0xf
    v_add_f32_dpp v87, v23, v23 quad_perm:[2,3,0,1] row_mask:0xf bank_mask:0xf
    v_add_f32_dpp v84, v84, v84 row_half_mirror row_mask:0xf bank_mask:0xf
    v_add_f32_dpp v85, v85, v85 row_half_mirror row_mask:0xf bank_mask:0xf
    v_add_f32_dpp v86, v86, v86 row_half_mirror row_mask:0xf bank_mask:0xf
    v_add_f32_dpp v87, v87, v87 row_half_mirror row_mask:0xf bank_mask:0xf
    v_add_f32_dpp v20, v88, v88 quad_perm:[1,0,3,2] row_mask:0xf bank_mask:0xf
    v_add_f32_dpp v21, v89, v89 quad_perm:[1,0,3,2] row_mask:0xf bank_mask:0xf
    v_add_f32_dpp v22, v90, v90 quad_perm:[1,0,3,2] row_mask:0xf bank_mask:0xf
    v_add_f32_dpp v23, v91, v91 quad_perm:[1,0,3,2] row_mask:0xf bank_mask:0xf
    v_add_f32_dpp v88, v20, v20 quad_perm:[2,3,0,1] row_mask:0xf bank_mask:0xf
    v_add_f32_dpp v89, v21, v21 quad_perm:[2,3,0,1] row_mask:0xf bank_mask:0xf
    v_add_f32_dpp v90, v22, v22 quad_perm:[2,3,0,1] row_mask:0xf bank_mask:0xf
    v_add_f32_dpp v91, v23, v23 quad_perm:[2,3,0,1] row_mask:0xf bank_mask:0xf
    v_add_f32_dpp v88, v88, v88 row_half_mirror row_mask:0xf bank_mask:0xf
    v_add_f32_dpp v89, v89, v89 row_half_mirror row_mask:0xf bank_mask:0xf
    v_add_f32_dpp v90, v90, v90 row_half_mirror row_mask:0xf bank_mask:0xf
    v_add_f32_dpp v91, v91, v91 row_half_mirror row_mask:0xf bank_mask:0xf
    s_cmp_eq_u32 s5, 13
    s_cselect_b32 s39, 2, 4
    v_cmp_gt_u32 vcc, s39, v2
    v_cvt_pk_bf16_f32 v60, v60, v60
    v_lshlrev_b32 v60, 16, v60
    v_lshlrev_b32 v18, 16, v224
    v_add_f32 v60, v60, v18
    v_cvt_pk_bf16_f32 v60, v60, v60
    v_lshlrev_b32 v60, 16, v60
    v_max_f32 v60, 0, v60
    v_mul_f32 v60, v60, v60
    v_cvt_pk_bf16_f32 v61, v61, v61
    v_lshlrev_b32 v61, 16, v61
    v_and_b32 v18, 0xffff0000, v224
    v_add_f32 v61, v61, v18
    v_cvt_pk_bf16_f32 v61, v61, v61
    v_lshlrev_b32 v61, 16, v61
    v_max_f32 v61, 0, v61
    v_mul_f32 v61, v61, v61
    v_cvt_pk_bf16_f32 v40, v60, v61
    v_cndmask_b32 v40, 0, v40, vcc
    v_cvt_pk_bf16_f32 v62, v62, v62
    v_lshlrev_b32 v62, 16, v62
    v_lshlrev_b32 v18, 16, v225
    v_add_f32 v62, v62, v18
    v_cvt_pk_bf16_f32 v62, v62, v62
    v_lshlrev_b32 v62, 16, v62
    v_max_f32 v62, 0, v62
    v_mul_f32 v62, v62, v62
    v_cvt_pk_bf16_f32 v63, v63, v63
    v_lshlrev_b32 v63, 16, v63
    v_and_b32 v18, 0xffff0000, v225
    v_add_f32 v63, v63, v18
    v_cvt_pk_bf16_f32 v63, v63, v63
    v_lshlrev_b32 v63, 16, v63
    v_max_f32 v63, 0, v63
    v_mul_f32 v63, v63, v63
    v_cvt_pk_bf16_f32 v41, v62, v63
    v_cndmask_b32 v41, 0, v41, vcc
    v_cvt_pk_bf16_f32 v64, v64, v64
    v_lshlrev_b32 v64, 16, v64
    v_lshlrev_b32 v18, 16, v226
    v_add_f32 v64, v64, v18
    v_cvt_pk_bf16_f32 v64, v64, v64
    v_lshlrev_b32 v64, 16, v64
    v_max_f32 v64, 0, v64
    v_mul_f32 v64, v64, v64
    v_cvt_pk_bf16_f32 v65, v65, v65
    v_lshlrev_b32 v65, 16, v65
    v_and_b32 v18, 0xffff0000, v226
    v_add_f32 v65, v65, v18
    v_cvt_pk_bf16_f32 v65, v65, v65
    v_lshlrev_b32 v65, 16, v65
    v_max_f32 v65, 0, v65
    v_mul_f32 v65, v65, v65
    v_cvt_pk_bf16_f32 v42, v64, v65
    v_cndmask_b32 v42, 0, v42, vcc
    v_cvt_pk_bf16_f32 v66, v66, v66
    v_lshlrev_b32 v66, 16, v66
    v_lshlrev_b32 v18, 16, v227
    v_add_f32 v66, v66, v18
    v_cvt_pk_bf16_f32 v66, v66, v66
    v_lshlrev_b32 v66, 16, v66
    v_max_f32 v66, 0, v66
    v_mul_f32 v66, v66, v66
    v_cvt_pk_bf16_f32 v67, v67, v67
    v_lshlrev_b32 v67, 16, v67
    v_and_b32 v18, 0xffff0000, v227
    v_add_f32 v67, v67, v18
    v_cvt_pk_bf16_f32 v67, v67, v67
    v_lshlrev_b32 v67, 16, v67
    v_max_f32 v67, 0, v67
    v_mul_f32 v67, v67, v67
    v_cvt_pk_bf16_f32 v43, v66, v67
    v_cndmask_b32 v43, 0, v43, vcc
    v_cvt_pk_bf16_f32 v68, v68, v68
    v_lshlrev_b32 v68, 16, v68
    v_lshlrev_b32 v18, 16, v228
    v_add_f32 v68, v68, v18
    v_cvt_pk_bf16_f32 v68, v68, v68
    v_lshlrev_b32 v68, 16, v68
    v_max_f32 v68, 0, v68
    v_mul_f32 v68, v68, v68
    v_cvt_pk_bf16_f32 v69, v69, v69
    v_lshlrev_b32 v69, 16, v69
    v_and_b32 v18, 0xffff0000, v228
    v_add_f32 v69, v69, v18
    v_cvt_pk_bf16_f32 v69, v69, v69
    v_lshlrev_b32 v69, 16, v69
    v_max_f32 v69, 0, v69
    v_mul_f32 v69, v69, v69
    v_cvt_pk_bf16_f32 v44, v68, v69
    v_cndmask_b32 v44, 0, v44, vcc
    v_cvt_pk_bf16_f32 v70, v70, v70
    v_lshlrev_b32 v70, 16, v70
    v_lshlrev_b32 v18, 16, v229
    v_add_f32 v70, v70, v18
    v_cvt_pk_bf16_f32 v70, v70, v70
    v_lshlrev_b32 v70, 16, v70
    v_max_f32 v70, 0, v70
    v_mul_f32 v70, v70, v70
    v_cvt_pk_bf16_f32 v71, v71, v71
    v_lshlrev_b32 v71, 16, v71
    v_and_b32 v18, 0xffff0000, v229
    v_add_f32 v71, v71, v18
    v_cvt_pk_bf16_f32 v71, v71, v71
    v_lshlrev_b32 v71, 16, v71
    v_max_f32 v71, 0, v71
    v_mul_f32 v71, v71, v71
    v_cvt_pk_bf16_f32 v45, v70, v71
    v_cndmask_b32 v45, 0, v45, vcc
    v_cvt_pk_bf16_f32 v72, v72, v72
    v_lshlrev_b32 v72, 16, v72
    v_lshlrev_b32 v18, 16, v230
    v_add_f32 v72, v72, v18
    v_cvt_pk_bf16_f32 v72, v72, v72
    v_lshlrev_b32 v72, 16, v72
    v_max_f32 v72, 0, v72
    v_mul_f32 v72, v72, v72
    v_cvt_pk_bf16_f32 v73, v73, v73
    v_lshlrev_b32 v73, 16, v73
    v_and_b32 v18, 0xffff0000, v230
    v_add_f32 v73, v73, v18
    v_cvt_pk_bf16_f32 v73, v73, v73
    v_lshlrev_b32 v73, 16, v73
    v_max_f32 v73, 0, v73
    v_mul_f32 v73, v73, v73
    v_cvt_pk_bf16_f32 v46, v72, v73
    v_cndmask_b32 v46, 0, v46, vcc
    v_cvt_pk_bf16_f32 v74, v74, v74
    v_lshlrev_b32 v74, 16, v74
    v_lshlrev_b32 v18, 16, v231
    v_add_f32 v74, v74, v18
    v_cvt_pk_bf16_f32 v74, v74, v74
    v_lshlrev_b32 v74, 16, v74
    v_max_f32 v74, 0, v74
    v_mul_f32 v74, v74, v74
    v_cvt_pk_bf16_f32 v75, v75, v75
    v_lshlrev_b32 v75, 16, v75
    v_and_b32 v18, 0xffff0000, v231
    v_add_f32 v75, v75, v18
    v_cvt_pk_bf16_f32 v75, v75, v75
    v_lshlrev_b32 v75, 16, v75
    v_max_f32 v75, 0, v75
    v_mul_f32 v75, v75, v75
    v_cvt_pk_bf16_f32 v47, v74, v75
    v_cndmask_b32 v47, 0, v47, vcc
    v_cvt_pk_bf16_f32 v76, v76, v76
    v_lshlrev_b32 v76, 16, v76
    v_lshlrev_b32 v18, 16, v232
    v_add_f32 v76, v76, v18
    v_cvt_pk_bf16_f32 v76, v76, v76
    v_lshlrev_b32 v76, 16, v76
    v_max_f32 v76, 0, v76
    v_mul_f32 v76, v76, v76
    v_cvt_pk_bf16_f32 v77, v77, v77
    v_lshlrev_b32 v77, 16, v77
    v_and_b32 v18, 0xffff0000, v232
    v_add_f32 v77, v77, v18
    v_cvt_pk_bf16_f32 v77, v77, v77
    v_lshlrev_b32 v77, 16, v77
    v_max_f32 v77, 0, v77
    v_mul_f32 v77, v77, v77
    v_cvt_pk_bf16_f32 v48, v76, v77
    v_cndmask_b32 v48, 0, v48, vcc
    v_cvt_pk_bf16_f32 v78, v78, v78
    v_lshlrev_b32 v78, 16, v78
    v_lshlrev_b32 v18, 16, v233
    v_add_f32 v78, v78, v18
    v_cvt_pk_bf16_f32 v78, v78, v78
    v_lshlrev_b32 v78, 16, v78
    v_max_f32 v78, 0, v78
    v_mul_f32 v78, v78, v78
    v_cvt_pk_bf16_f32 v79, v79, v79
    v_lshlrev_b32 v79, 16, v79
    v_and_b32 v18, 0xffff0000, v233
    v_add_f32 v79, v79, v18
    v_cvt_pk_bf16_f32 v79, v79, v79
    v_lshlrev_b32 v79, 16, v79
    v_max_f32 v79, 0, v79
    v_mul_f32 v79, v79, v79
    v_cvt_pk_bf16_f32 v49, v78, v79
    v_cndmask_b32 v49, 0, v49, vcc
    v_cvt_pk_bf16_f32 v80, v80, v80
    v_lshlrev_b32 v80, 16, v80
    v_lshlrev_b32 v18, 16, v234
    v_add_f32 v80, v80, v18
    v_cvt_pk_bf16_f32 v80, v80, v80
    v_lshlrev_b32 v80, 16, v80
    v_max_f32 v80, 0, v80
    v_mul_f32 v80, v80, v80
    v_cvt_pk_bf16_f32 v81, v81, v81
    v_lshlrev_b32 v81, 16, v81
    v_and_b32 v18, 0xffff0000, v234
    v_add_f32 v81, v81, v18
    v_cvt_pk_bf16_f32 v81, v81, v81
    v_lshlrev_b32 v81, 16, v81
    v_max_f32 v81, 0, v81
    v_mul_f32 v81, v81, v81
    v_cvt_pk_bf16_f32 v50, v80, v81
    v_cndmask_b32 v50, 0, v50, vcc
    v_cvt_pk_bf16_f32 v82, v82, v82
    v_lshlrev_b32 v82, 16, v82
    v_lshlrev_b32 v18, 16, v235
    v_add_f32 v82, v82, v18
    v_cvt_pk_bf16_f32 v82, v82, v82
    v_lshlrev_b32 v82, 16, v82
    v_max_f32 v82, 0, v82
    v_mul_f32 v82, v82, v82
    v_cvt_pk_bf16_f32 v83, v83, v83
    v_lshlrev_b32 v83, 16, v83
    v_and_b32 v18, 0xffff0000, v235
    v_add_f32 v83, v83, v18
    v_cvt_pk_bf16_f32 v83, v83, v83
    v_lshlrev_b32 v83, 16, v83
    v_max_f32 v83, 0, v83
    v_mul_f32 v83, v83, v83
    v_cvt_pk_bf16_f32 v51, v82, v83
    v_cndmask_b32 v51, 0, v51, vcc
    v_cvt_pk_bf16_f32 v84, v84, v84
    v_lshlrev_b32 v84, 16, v84
    v_lshlrev_b32 v18, 16, v236
    v_add_f32 v84, v84, v18
    v_cvt_pk_bf16_f32 v84, v84, v84
    v_lshlrev_b32 v84, 16, v84
    v_max_f32 v84, 0, v84
    v_mul_f32 v84, v84, v84
    v_cvt_pk_bf16_f32 v85, v85, v85
    v_lshlrev_b32 v85, 16, v85
    v_and_b32 v18, 0xffff0000, v236
    v_add_f32 v85, v85, v18
    v_cvt_pk_bf16_f32 v85, v85, v85
    v_lshlrev_b32 v85, 16, v85
    v_max_f32 v85, 0, v85
    v_mul_f32 v85, v85, v85
    v_cvt_pk_bf16_f32 v52, v84, v85
    v_cndmask_b32 v52, 0, v52, vcc
    v_cvt_pk_bf16_f32 v86, v86, v86
    v_lshlrev_b32 v86, 16, v86
    v_lshlrev_b32 v18, 16, v237
    v_add_f32 v86, v86, v18
    v_cvt_pk_bf16_f32 v86, v86, v86
    v_lshlrev_b32 v86, 16, v86
    v_max_f32 v86, 0, v86
    v_mul_f32 v86, v86, v86
    v_cvt_pk_bf16_f32 v87, v87, v87
    v_lshlrev_b32 v87, 16, v87
    v_and_b32 v18, 0xffff0000, v237
    v_add_f32 v87, v87, v18
    v_cvt_pk_bf16_f32 v87, v87, v87
    v_lshlrev_b32 v87, 16, v87
    v_max_f32 v87, 0, v87
    v_mul_f32 v87, v87, v87
    v_cvt_pk_bf16_f32 v53, v86, v87
    v_cndmask_b32 v53, 0, v53, vcc
    v_cvt_pk_bf16_f32 v88, v88, v88
    v_lshlrev_b32 v88, 16, v88
    v_lshlrev_b32 v18, 16, v238
    v_add_f32 v88, v88, v18
    v_cvt_pk_bf16_f32 v88, v88, v88
    v_lshlrev_b32 v88, 16, v88
    v_max_f32 v88, 0, v88
    v_mul_f32 v88, v88, v88
    v_cvt_pk_bf16_f32 v89, v89, v89
    v_lshlrev_b32 v89, 16, v89
    v_and_b32 v18, 0xffff0000, v238
    v_add_f32 v89, v89, v18
    v_cvt_pk_bf16_f32 v89, v89, v89
    v_lshlrev_b32 v89, 16, v89
    v_max_f32 v89, 0, v89
    v_mul_f32 v89, v89, v89
    v_cvt_pk_bf16_f32 v54, v88, v89
    v_cndmask_b32 v54, 0, v54, vcc
    v_cvt_pk_bf16_f32 v90, v90, v90
    v_lshlrev_b32 v90, 16, v90
    v_lshlrev_b32 v18, 16, v239
    v_add_f32 v90, v90, v18
    v_cvt_pk_bf16_f32 v90, v90, v90
    v_lshlrev_b32 v90, 16, v90
    v_max_f32 v90, 0, v90
    v_mul_f32 v90, v90, v90
    v_cvt_pk_bf16_f32 v91, v91, v91
    v_lshlrev_b32 v91, 16, v91
    v_and_b32 v18, 0xffff0000, v239
    v_add_f32 v91, v91, v18
    v_cvt_pk_bf16_f32 v91, v91, v91
    v_lshlrev_b32 v91, 16, v91
    v_max_f32 v91, 0, v91
    v_mul_f32 v91, v91, v91
    v_cvt_pk_bf16_f32 v55, v90, v91
    v_cndmask_b32 v55, 0, v55, vcc
    v_perm_b32 v32, v40, v40, v4
    v_perm_b32 v33, v40, v40, v5
    v_perm_b32 v34, v40, v40, v6
    v_perm_b32 v35, v40, v40, v7
    v_perm_b32 v36, v40, v40, v8
    v_perm_b32 v37, v40, v40, v9
    v_perm_b32 v38, v40, v40, v10
    v_perm_b32 v39, v40, v40, v11
    v_mfma_f32_16x16x32_bf16 v[12:15], v[32:35], v[96:99], 0
    v_perm_b32 v32, v41, v41, v4
    v_perm_b32 v33, v41, v41, v5
    v_perm_b32 v34, v41, v41, v6
    v_perm_b32 v35, v41, v41, v7
    v_mfma_f32_16x16x32_bf16 v[12:15], v[36:39], v[100:103], v[12:15]
    v_perm_b32 v36, v41, v41, v8
    v_perm_b32 v37, v41, v41, v9
    v_perm_b32 v38, v41, v41, v10
    v_perm_b32 v39, v41, v41, v11
    v_mfma_f32_16x16x32_bf16 v[12:15], v[32:35], v[104:107], v[12:15]
    v_perm_b32 v32, v42, v42, v4
    v_perm_b32 v33, v42, v42, v5
    v_perm_b32 v34, v42, v42, v6
    v_perm_b32 v35, v42, v42, v7
    v_mfma_f32_16x16x32_bf16 v[12:15], v[36:39], v[108:111], v[12:15]
    v_perm_b32 v36, v42, v42, v8
    v_perm_b32 v37, v42, v42, v9
    v_perm_b32 v38, v42, v42, v10
    v_perm_b32 v39, v42, v42, v11
    v_mfma_f32_16x16x32_bf16 v[12:15], v[32:35], v[112:115], v[12:15]
    v_perm_b32 v32, v43, v43, v4
    v_perm_b32 v33, v43, v43, v5
    v_perm_b32 v34, v43, v43, v6
    v_perm_b32 v35, v43, v43, v7
    v_mfma_f32_16x16x32_bf16 v[12:15], v[36:39], v[116:119], v[12:15]
    v_perm_b32 v36, v43, v43, v8
    v_perm_b32 v37, v43, v43, v9
    v_perm_b32 v38, v43, v43, v10
    v_perm_b32 v39, v43, v43, v11
    v_mfma_f32_16x16x32_bf16 v[12:15], v[32:35], v[120:123], v[12:15]
    v_perm_b32 v32, v44, v44, v4
    v_perm_b32 v33, v44, v44, v5
    v_perm_b32 v34, v44, v44, v6
    v_perm_b32 v35, v44, v44, v7
    v_mfma_f32_16x16x32_bf16 v[12:15], v[36:39], v[124:127], v[12:15]
    v_perm_b32 v36, v44, v44, v8
    v_perm_b32 v37, v44, v44, v9
    v_perm_b32 v38, v44, v44, v10
    v_perm_b32 v39, v44, v44, v11
    v_mfma_f32_16x16x32_bf16 v[12:15], v[32:35], v[128:131], v[12:15]
    v_perm_b32 v32, v45, v45, v4
    v_perm_b32 v33, v45, v45, v5
    v_perm_b32 v34, v45, v45, v6
    v_perm_b32 v35, v45, v45, v7
    v_mfma_f32_16x16x32_bf16 v[12:15], v[36:39], v[132:135], v[12:15]
    v_perm_b32 v36, v45, v45, v8
    v_perm_b32 v37, v45, v45, v9
    v_perm_b32 v38, v45, v45, v10
    v_perm_b32 v39, v45, v45, v11
    v_mfma_f32_16x16x32_bf16 v[12:15], v[32:35], v[136:139], v[12:15]
    v_perm_b32 v32, v46, v46, v4
    v_perm_b32 v33, v46, v46, v5
    v_perm_b32 v34, v46, v46, v6
    v_perm_b32 v35, v46, v46, v7
    v_mfma_f32_16x16x32_bf16 v[12:15], v[36:39], v[140:143], v[12:15]
    v_perm_b32 v36, v46, v46, v8
    v_perm_b32 v37, v46, v46, v9
    v_perm_b32 v38, v46, v46, v10
    v_perm_b32 v39, v46, v46, v11
    v_mfma_f32_16x16x32_bf16 v[12:15], v[32:35], v[144:147], v[12:15]
    v_perm_b32 v32, v47, v47, v4
    v_perm_b32 v33, v47, v47, v5
    v_perm_b32 v34, v47, v47, v6
    v_perm_b32 v35, v47, v47, v7
    v_mfma_f32_16x16x32_bf16 v[12:15], v[36:39], v[148:151], v[12:15]
    v_perm_b32 v36, v47, v47, v8
    v_perm_b32 v37, v47, v47, v9
    v_perm_b32 v38, v47, v47, v10
    v_perm_b32 v39, v47, v47, v11
    v_mfma_f32_16x16x32_bf16 v[12:15], v[32:35], v[152:155], v[12:15]
    v_perm_b32 v32, v48, v48, v4
    v_perm_b32 v33, v48, v48, v5
    v_perm_b32 v34, v48, v48, v6
    v_perm_b32 v35, v48, v48, v7
    v_mfma_f32_16x16x32_bf16 v[12:15], v[36:39], v[156:159], v[12:15]
    v_perm_b32 v36, v48, v48, v8
    v_perm_b32 v37, v48, v48, v9
    v_perm_b32 v38, v48, v48, v10
    v_perm_b32 v39, v48, v48, v11
    v_mfma_f32_16x16x32_bf16 v[12:15], v[32:35], v[160:163], v[12:15]
    v_perm_b32 v32, v49, v49, v4
    v_perm_b32 v33, v49, v49, v5
    v_perm_b32 v34, v49, v49, v6
    v_perm_b32 v35, v49, v49, v7
    v_mfma_f32_16x16x32_bf16 v[12:15], v[36:39], v[164:167], v[12:15]
    v_perm_b32 v36, v49, v49, v8
    v_perm_b32 v37, v49, v49, v9
    v_perm_b32 v38, v49, v49, v10
    v_perm_b32 v39, v49, v49, v11
    v_mfma_f32_16x16x32_bf16 v[12:15], v[32:35], v[168:171], v[12:15]
    v_perm_b32 v32, v50, v50, v4
    v_perm_b32 v33, v50, v50, v5
    v_perm_b32 v34, v50, v50, v6
    v_perm_b32 v35, v50, v50, v7
    v_mfma_f32_16x16x32_bf16 v[12:15], v[36:39], v[172:175], v[12:15]
    v_perm_b32 v36, v50, v50, v8
    v_perm_b32 v37, v50, v50, v9
    v_perm_b32 v38, v50, v50, v10
    v_perm_b32 v39, v50, v50, v11
    v_mfma_f32_16x16x32_bf16 v[12:15], v[32:35], v[176:179], v[12:15]
    v_perm_b32 v32, v51, v51, v4
    v_perm_b32 v33, v51, v51, v5
    v_perm_b32 v34, v51, v51, v6
    v_perm_b32 v35, v51, v51, v7
    v_mfma_f32_16x16x32_bf16 v[12:15], v[36:39], v[180:183], v[12:15]
    v_perm_b32 v36, v51, v51, v8
    v_perm_b32 v37, v51, v51, v9
    v_perm_b32 v38, v51, v51, v10
    v_perm_b32 v39, v51, v51, v11
    v_mfma_f32_16x16x32_bf16 v[12:15], v[32:35], v[184:187], v[12:15]
    v_perm_b32 v32, v52, v52, v4
    v_perm_b32 v33, v52, v52, v5
    v_perm_b32 v34, v52, v52, v6
    v_perm_b32 v35, v52, v52, v7
    v_mfma_f32_16x16x32_bf16 v[12:15], v[36:39], v[188:191], v[12:15]
    v_perm_b32 v36, v52, v52, v8
    v_perm_b32 v37, v52, v52, v9
    v_perm_b32 v38, v52, v52, v10
    v_perm_b32 v39, v52, v52, v11
    v_mfma_f32_16x16x32_bf16 v[12:15], v[32:35], v[192:195], v[12:15]
    v_perm_b32 v32, v53, v53, v4
    v_perm_b32 v33, v53, v53, v5
    v_perm_b32 v34, v53, v53, v6
    v_perm_b32 v35, v53, v53, v7
    v_mfma_f32_16x16x32_bf16 v[12:15], v[36:39], v[196:199], v[12:15]
    v_perm_b32 v36, v53, v53, v8
    v_perm_b32 v37, v53, v53, v9
    v_perm_b32 v38, v53, v53, v10
    v_perm_b32 v39, v53, v53, v11
    v_mfma_f32_16x16x32_bf16 v[12:15], v[32:35], v[200:203], v[12:15]
    v_perm_b32 v32, v54, v54, v4
    v_perm_b32 v33, v54, v54, v5
    v_perm_b32 v34, v54, v54, v6
    v_perm_b32 v35, v54, v54, v7
    v_mfma_f32_16x16x32_bf16 v[12:15], v[36:39], v[204:207], v[12:15]
    v_perm_b32 v36, v54, v54, v8
    v_perm_b32 v37, v54, v54, v9
    v_perm_b32 v38, v54, v54, v10
    v_perm_b32 v39, v54, v54, v11
    v_mfma_f32_16x16x32_bf16 v[12:15], v[32:35], v[208:211], v[12:15]
    v_perm_b32 v32, v55, v55, v4
    v_perm_b32 v33, v55, v55, v5
    v_perm_b32 v34, v55, v55, v6
    v_perm_b32 v35, v55, v55, v7
    v_mfma_f32_16x16x32_bf16 v[12:15], v[36:39], v[212:215], v[12:15]
    v_perm_b32 v36, v55, v55, v8
    v_perm_b32 v37, v55, v55, v9
    v_perm_b32 v38, v55, v55, v10
    v_perm_b32 v39, v55, v55, v11
    v_mfma_f32_16x16x32_bf16 v[12:15], v[32:35], v[216:219], v[12:15]
    s_nop 0
    v_mfma_f32_16x16x32_bf16 v[12:15], v[36:39], v[220:223], v[12:15]
    s_nop 7
    v_add_u32 v20, 0x800, v12
    v_bfi_b32 v20, v244, v240, v20
    v_add_u32 v21, 0x800, v13
    v_bfi_b32 v21, v244, v241, v21
    v_add_u32 v22, 0x800, v14
    v_bfi_b32 v22, v244, v242, v22
    v_add_u32 v23, 0x800, v15
    v_bfi_b32 v23, v244, v243, v23
    buffer_store_dwordx4 v[20:23], v93, s[48:51], s59 offen sc1
    s_endpgm
L_hp:
    s_getpc_b64 s[60:61]
L_pc:
    s_sub_u32 s60, s60, L_pc-recurrent_scan__mha_block_cached__dense_activation_squared_relu__decode_kernel
    s_subb_u32 s61, s61, 0
    s_mov_b32 s62, L_end-recurrent_scan__mha_block_cached__dense_activation_squared_relu__decode_kernel
    s_mov_b32 s63, 0x20000
    s_lshr_b32 s39, s2, 3
    s_lshl_b32 s39, s39, 10
    v_lshlrev_b32 v6, 4, v1
    buffer_load_dwordx4 v[8:11], v6, s[60:63], s39 offen
    v_mov_b32 v4, 0
    v_lshlrev_b32 v5, 2, v1
    ds_write_b32 v5, v4 offset:256
    s_waitcnt lgkmcnt(0)
    s_load_dwordx2 s[74:75], s[32:33], 49152
    s_mov_b32 s48, s32
    s_mov_b32 s49, s33
    v_and_b32 v94, 7, v3
    v_lshrrev_b32 v95, 3, v3
    s_getreg_b32 s39, hwreg(HW_REG_XCC_ID, 0, 4)
    v_mov_b32 v20, s39
    v_mov_b32 v22, 0
    v_lshlrev_b32 v24, 24, v1
    s_lshl_b32 s39, s34, 3
    s_add_u32 s39, s39, s4
    s_lshl_b32 s39, s39, 4
    s_add_u32 s39, s39, 40960
    s_waitcnt lgkmcnt(0)
    s_add_u32 s74, s74, 0x7f4a7c15
    s_addc_u32 s75, s75, 0x9e3779b9
    s_and_b32 s70, s74, 0xfff
    s_bfe_u32 s71, s74, 0xc000c
    s_lshr_b64 s[72:73], s[74:75], 24
    s_bfe_u32 s73, s72, 0xc000c
    s_and_b32 s72, s72, 0xfff
    v_mov_b32 v21, s74
    v_mov_b32 v23, s75
    buffer_store_dwordx4 v[20:23], v24, s[48:51], s39 offen
    s_barrier
    s_mov_b32 s67, 1048576
    v_mov_b32 v16, 256
L_pw44:
    ds_read_b32 v17, v16
    s_waitcnt lgkmcnt(0)
    v_readfirstlane_b32 s39, v17
    s_cmp_ge_u32 s39, 1
    s_cbranch_scc1 L_pd44
    s_sleep 8
    s_sub_u32 s67, s67, 1
    s_cmp_lg_u32 s67, 0
    s_cbranch_scc1 L_pw44
L_pd44:
    v_and_b32 v30, 7, v1
    v_lshlrev_b32 v30, 4, v30
    s_lshl_b32 s39, s34, 7
    s_add_u32 s39, s39, 40960
    buffer_load_dwordx4 v[40:43], v30, s[48:51], s39 offen sc1
    s_waitcnt vmcnt(0)
    s_getreg_b32 s39, hwreg(HW_REG_XCC_ID, 0, 4)
    v_xor_b32 v40, s39, v40
    v_xor_b32 v41, s74, v41
    v_xor_b32 v43, s75, v43
    v_or3_b32 v40, v40, v41, v43
    v_cmp_ne_u32 vcc, 0, v40
    s_nop 1
    s_cmp_eq_u64 vcc, 0
    s_cselect_b32 s46, 1, 2
    s_mov_b32 s67, 1048576
    v_mov_b32 v16, 256
L_pw45:
    ds_read_b32 v17, v16
    s_waitcnt lgkmcnt(0)
    v_readfirstlane_b32 s39, v17
    s_cmp_ge_u32 s39, 2
    s_cbranch_scc1 L_pd45
    s_sleep 2
    s_sub_u32 s67, s67, 1
    s_cmp_lg_u32 s67, 0
    s_cbranch_scc1 L_pw45
L_pd45:
    s_memrealtime s[8:9]
    s_mov_b32 s67, 1048576
    v_mov_b32 v16, 256
L_pw46:
    ds_read_b32 v17, v16
    s_waitcnt lgkmcnt(0)
    v_readfirstlane_b32 s39, v17
    s_cmp_ge_u32 s39, 4
    s_cbranch_scc1 L_pd46
    s_sleep 2
    s_sub_u32 s67, s67, 1
    s_cmp_lg_u32 s67, 0
    s_cbranch_scc1 L_pw46
L_pd46:
    s_memrealtime s[10:11]
    s_waitcnt lgkmcnt(0)
    v_mov_b32 v20, s8
    v_mov_b32 v21, s74
    v_mov_b32 v22, s10
    v_mov_b32 v23, s75
    v_lshlrev_b32 v24, 24, v1
    s_lshr_b32 s39, s2, 5
    s_lshl_b32 s39, s39, 3
    s_and_b32 s12, s2, 7
    s_add_u32 s39, s39, s12
    s_lshl_b32 s39, s39, 4
    s_lshl_b32 s12, s37, 24
    s_add_u32 s39, s39, s12
    s_add_u32 s39, s39, 32768
    buffer_store_dwordx4 v[20:23], v24, s[48:51], s39 offen sc1
    s_mov_b32 s67, 1048576
    v_mov_b32 v16, 256
L_pw47:
    ds_read_b32 v17, v16
    s_waitcnt lgkmcnt(0)
    v_readfirstlane_b32 s39, v17
    s_cmp_ge_u32 s39, 5
    s_cbranch_scc1 L_pd47
    s_sleep 4
    s_sub_u32 s67, s67, 1
    s_cmp_lg_u32 s67, 0
    s_cbranch_scc1 L_pw47
L_pd47:
    v_lshlrev_b32 v24, 4, v1
    s_mov_b32 s39, 32768
    buffer_load_dwordx4 v[60:63], v24, s[48:51], s39 offen offset:0 sc1
    v_mov_b32 v26, 0
    v_mov_b32 v27, 0
    s_sub_u32 s12, s8, s10
    v_mov_b32 v28, s12
    s_waitcnt vmcnt(0)
    v_cmp_eq_u32 vcc, s74, v61
    v_subrev_u32 v60, s10, v60
    v_subrev_u32 v62, s10, v62
    v_cndmask_b32 v60, v28, v60, vcc
    v_cndmask_b32 v62, 0, v62, vcc
    v_add_u32 v26, v26, v60
    v_add_u32 v27, v27, v62
    s_nop 0
    v_add_u32_dpp v29, v26, v26 quad_perm:[1,0,3,2] row_mask:0xf bank_mask:0xf
    v_add_u32_dpp v30, v27, v27 quad_perm:[1,0,3,2] row_mask:0xf bank_mask:0xf
    s_nop 0
    v_add_u32_dpp v26, v29, v29 quad_perm:[2,3,0,1] row_mask:0xf bank_mask:0xf
    v_add_u32_dpp v27, v30, v30 quad_perm:[2,3,0,1] row_mask:0xf bank_mask:0xf
    s_nop 0
    v_add_u32_dpp v26, v26, v26 row_half_mirror row_mask:0xf bank_mask:0xf
    v_add_u32_dpp v27, v27, v27 row_half_mirror row_mask:0xf bank_mask:0xf
    s_nop 0
    v_add_u32_dpp v26, v26, v26 row_ror:8 row_mask:0xf bank_mask:0xf
    v_add_u32_dpp v27, v27, v27 row_ror:8 row_mask:0xf bank_mask:0xf
    v_mov_b32 v29, v26
    s_nop 1
    v_permlane16_swap_b32 v26, v29
    v_add_u32 v26, v26, v29
    v_mov_b32 v29, v26
    s_nop 1
    v_permlane32_swap_b32 v26, v29
    v_add_u32 v26, v26, v29
    v_mov_b32 v30, v27
    s_nop 1
    v_permlane16_swap_b32 v27, v30
    v_add_u32 v27, v27, v30
    v_mov_b32 v30, v27
    s_nop 1
    v_permlane32_swap_b32 v27, v30
    v_add_u32 v27, v27, v30
    v_readfirstlane_b32 s12, v26
    v_readfirstlane_b32 s13, v27
    s_sub_u32 s14, s13, s12
    s_mul_i32 s14, s14, 256
    s_ashr_i32 s14, s14, 14
    s_ashr_i32 s13, s13, 2
    s_add_u32 s15, s10, 0
    s_lshl_b32 s15, s15, 4
    s_add_u32 s15, s15, s13
    s_lshl_b32 s12, s14, 3
    s_add_u32 s15, s15, s12
    v_mov_b32 v26, s15
    v_mov_b32 v27, s14
    v_mov_b32 v28, 264
    ds_write_b64 v28, v[26:27]
    s_mov_b32 s67, 1048576
    v_mov_b32 v16, 284
L_pw48:
    ds_read_b32 v17, v16
    s_waitcnt lgkmcnt(0)
    v_readfirstlane_b32 s39, v17
    s_cmp_ge_u32 s39, 4
    s_cbranch_scc1 L_pd48
    s_sleep 4
    s_sub_u32 s67, s67, 1
    s_cmp_lg_u32 s67, 0
    s_cbranch_scc1 L_pw48
L_pd48:
    v_and_b32 v16, 3, v1
    v_lshlrev_b32 v16, 4, v16
    ds_read_b128 v[20:23], v16 offset:320
    v_lshrrev_b32 v17, 2, v1
    v_lshl_add_u32 v16, v17, 24, v16
    s_lshl_b32 s39, s35, 8
    s_lshl_b32 s56, s37, 6
    s_add_u32 s39, s39, s56
    s_waitcnt lgkmcnt(0)
    s_cmp_eq_u32 s46, 1
    s_cbranch_scc0 L_mls
    buffer_store_dwordx4 v[20:23], v16, s[48:51], s39 offen
    s_branch L_mlt
L_mls:
    buffer_store_dwordx4 v[20:23], v16, s[48:51], s39 offen sc1
L_mlt:
    s_mov_b32 s67, 1048576
    v_mov_b32 v16, 256
L_pw49:
    ds_read_b32 v17, v16
    s_waitcnt lgkmcnt(0)
    v_readfirstlane_b32 s39, v17
    s_cmp_ge_u32 s39, 6
    s_cbranch_scc1 L_pd49
    s_sleep 8
    s_sub_u32 s67, s67, 1
    s_cmp_lg_u32 s67, 0
    s_cbranch_scc1 L_pw49
L_pd49:
    v_lshlrev_b32 v16, 4, v3
    s_lshl_b32 s39, s35, 8
    s_mov_b32 s67, 131072
L_gw50:
    buffer_load_dwordx4 v[20:23], v16, s[48:51], s39 offen sc1
    s_waitcnt vmcnt(0)
    v_xor_b32 v21, s74, v21
    v_xor_b32 v23, s75, v23
    v_or_b32 v18, v21, v23
    v_cmp_ne_u32 vcc, 0, v18
    s_nop 1
    s_cmp_eq_u64 vcc, 0
    s_cbranch_scc1 L_gd50
    s_sleep 32
    s_sub_u32 s67, s67, 1
    s_cmp_lg_u32 s67, 0
    s_cbranch_scc1 L_gw50
L_gd50:
    v_mov_b32 v28, v20
    s_nop 1
    v_max_f32_dpp v29, v28, v28 quad_perm:[1,0,3,2] row_mask:0xf bank_mask:0xf
    s_nop 1
    v_max_f32_dpp v28, v29, v29 quad_perm:[2,3,0,1] row_mask:0xf bank_mask:0xf
    s_nop 1
    v_max_f32_dpp v28, v28, v28 row_half_mirror row_mask:0xf bank_mask:0xf
    s_nop 1
    v_max_f32_dpp v28, v28, v28 row_ror:8 row_mask:0xf bank_mask:0xf
    v_sub_f32 v20, v20, v28
    v_exp_f32 v20, v20
    s_nop 0
    v_mul_f32 v22, v22, v20
    s_nop 1
    v_add_f32_dpp v29, v22, v22 quad_perm:[1,0,3,2] row_mask:0xf bank_mask:0xf
    s_nop 1
    v_add_f32_dpp v22, v29, v29 quad_perm:[2,3,0,1] row_mask:0xf bank_mask:0xf
    s_nop 1
    v_add_f32_dpp v22, v22, v22 row_half_mirror row_mask:0xf bank_mask:0xf
    s_nop 1
    v_add_f32_dpp v22, v22, v22 row_ror:8 row_mask:0xf bank_mask:0xf
    v_rcp_f32 v22, v22
    s_nop 0
    v_mul_f32 v44, v20, v22
    s_lshl_b32 s56, s37, 2
    v_subrev_u32 v16, s56, v1
    v_lshlrev_b32 v16, 2, v16
    s_lshl_b64 exec, 15, s56
    ds_write_b32 v16, v44 offset:288
    s_mov_b64 exec, -1
    v_mov_b32 v21, s46
    v_mov_b32 v23, 260
    s_waitcnt lgkmcnt(0)
    ds_write_b32 v23, v21
    v_lshlrev_b32 v16, 4, v1
    s_lshl_b32 s39, s34, 12
    s_add_u32 s39, s39, 524288
    s_mov_b32 s67, 1048576
    v_mov_b32 v18, 256
L_pw51:
    ds_read_b32 v19, v18
    s_waitcnt lgkmcnt(0)
    v_readfirstlane_b32 s39, v19
    s_cmp_ge_u32 s39, 7
    s_cbranch_scc1 L_pd51
    s_sleep 8
    s_sub_u32 s67, s67, 1
    s_cmp_lg_u32 s67, 0
    s_cbranch_scc1 L_pw51
L_pd51:
    s_lshl_b32 s39, s34, 12
    s_add_u32 s39, s39, 524288
    s_lshl_b32 s56, s4, 9
    s_add_u32 s39, s39, s56
    v_lshlrev_b32 v16, 3, v1
    buffer_load_dwordx2 v[60:61], v16, s[48:51], s39 offen
L_end:
    s_endpgm
.section .rodata,"a"
.p2align 6
.amdhsa_kernel recurrent_scan__mha_block_cached__dense_activation_squared_relu__decode_kernel
  .amdhsa_next_free_vgpr 256
  .amdhsa_next_free_sgpr 100
  .amdhsa_accum_offset 256
  .amdhsa_group_segment_fixed_size 0
  .amdhsa_kernarg_size 104
  .amdhsa_user_sgpr_count 2
  .amdhsa_user_sgpr_kernarg_segment_ptr 1
  .amdhsa_system_sgpr_workgroup_id_x 1
.end_amdhsa_kernel
```
